```python
import torch

def _softmax(x, axis=-1):
    return torch.softmax(x, dim=axis)

def _gelu(x):
    return torch.nn.functional.gelu(x, approximate='tanh')

def _silu(x):
    return torch.nn.functional.silu(x)

def _sigmoid(x):
    return torch.sigmoid(x)

def _layernorm(x, axis=-1, eps=1e-05):
    m = x.mean(dim=axis, keepdim=True)
    v = x.var(dim=axis, keepdim=True, unbiased=False)
    return (x - m) / torch.sqrt(v + eps)

def _scatter_add(tgt, idx, src, axis=0):
    return tgt.clone().index_add_(axis, idx, src)

def _segment_sum(src, seg, n):
    out = torch.zeros((n,) + src.shape[1:], dtype=src.dtype)
    return out.index_add_(0, seg, src)

def _pad(x, pw):
    flat = tuple((v for pair in reversed(pw) for v in pair))
    return torch.nn.functional.pad(x, flat)
kernel_name = 'adaLN_cond__sliding_block_cached__geglu_ffn__decode'

def setup_inputs():

    _w = lambda a: (lambda t: t.to(torch.bfloat16) if t.is_floating_point() else t)(torch.as_tensor(a))

    def _A_setup():
        B, Sq, D = (1, 1, 576)
        Hq, Hkv, Sk, Dh = (32, 16, 65536, 128)
        assert Hq % Hkv == 0, (Hq, Hkv)
        return {'x': _w((lambda *s: torch.randn(*s, dtype=torch.bfloat16) * 0.05)(B, Sq, D)), 'k_cache': _w((lambda *s: torch.randn(*s, dtype=torch.bfloat16) * 3.2)(B, Hkv, Sk, Dh)), 'v_cache': _w((lambda *s: torch.randn(*s, dtype=torch.bfloat16) * 0.4)(B, Hkv, Sk, Dh)), 'wq': _w((lambda *s: torch.randn(*s, dtype=torch.bfloat16) * 3.2)(D, Hq * Dh) * D ** (-0.5)), 'wo': _w((lambda *s: torch.randn(*s, dtype=torch.bfloat16) * 0.4)(Hq * Dh, D) * (Hq * Dh) ** (-0.5))}
    _A_in = _A_setup()

    def _B_setup():
        B, S, D, F = (1, 1, 576, 4608)
        return {'x': _w((lambda *s: torch.randn(*s, dtype=torch.bfloat16) * 0.05)(B, S, D)), 'w_gate': _w((lambda *s: torch.randn(*s, dtype=torch.bfloat16) * 0.05)(D, F)), 'w_up': _w((lambda *s: torch.randn(*s, dtype=torch.bfloat16) * 0.05)(D, F)), 'w_down': _w((lambda *s: torch.randn(*s, dtype=torch.bfloat16) * 0.05)(F, D))}
    _B_in = _B_setup()
    return {'A_x': _A_in['x'], 'A_k_cache': _A_in['k_cache'], 'A_v_cache': _A_in['v_cache'], 'A_wq': _A_in['wq'], 'A_wo': _A_in['wo'], 'B_x': _B_in['x'], 'B_w_gate': _B_in['w_gate'], 'B_w_up': _B_in['w_up'], 'B_w_down': _B_in['w_down'], 'c': _w((lambda *s: torch.randn(*s, dtype=torch.bfloat16) * 0.1)(1, 576) * 8.0), 'w_mod': _w((lambda *s: torch.randn(*s, dtype=torch.bfloat16) * 0.1)(576, 6 * 576) * 576 ** (-0.5) * 8.0)}

def reference(A_x, A_k_cache, A_v_cache, A_wq, A_wo, B_x, B_w_gate, B_w_up, B_w_down, c, w_mod):

    def _A_ref(x, k_cache, v_cache, wq, wo):
        B, Sq, D = x.shape
        Hq, Dh = (32, 128)
        Hkv, Sk = (k_cache.shape[1], k_cache.shape[2])
        W = min(4096, max(256, Sk // 4))
        rep = Hq // Hkv
        q = (lambda x, *d: x.permute(*d))((x @ wq).reshape(B, Sq, Hq, Dh), 0, 2, 1, 3)
        k = (lambda x, n, axis: torch.repeat_interleave(x, n, dim=axis))(k_cache[:, :, Sk - W:, :], rep, axis=1)
        v = (lambda x, n, axis: torch.repeat_interleave(x, n, dim=axis))(v_cache[:, :, Sk - W:, :], rep, axis=1)
        scores = torch.einsum('bhqd,bhkd->bhqk', q, k) * Dh ** (-0.5)
        p = _softmax(scores, axis=-1)
        o = torch.einsum('bhqk,bhkd->bhqd', p, v)
        return (lambda x, *d: x.permute(*d))(o, 0, 2, 1, 3).reshape(B, Sq, Hq * Dh) @ wo

    def _B_ref(x, w_gate, w_up, w_down):
        return _gelu(x @ w_gate) * (x @ w_up) @ w_down
    x = A_x
    mod = (_silu(c) @ w_mod).reshape(c.shape[0], 6, 1, -1)
    sa, ca, ga, sb, cb, gb = (mod[:, 0].clone(), mod[:, 1].clone(), mod[:, 2].clone(), mod[:, 3].clone(), mod[:, 4].clone(), mod[:, 5].clone())
    h = _layernorm(x, axis=-1) * (1 + ca) + sa
    x = x + ga * _A_ref(h, A_k_cache, A_v_cache, A_wq, A_wo)
    h = _layernorm(x, axis=-1) * (1 + cb) + sb
    x = x + gb * _B_ref(h, B_w_gate, B_w_up, B_w_down)
    return x
```

```asm
; @launch grid=(256,1,1) block=(512,1,1) lds=141312
.amdgcn_target "amdgcn-amd-amdhsa--gfx950"
.text
.globl adaLN_cond__sliding_block_cached__geglu_ffn__decode_kernel
.p2align 8
.type adaLN_cond__sliding_block_cached__geglu_ffn__decode_kernel,@function
adaLN_cond__sliding_block_cached__geglu_ffn__decode_kernel:
  s_cmp_ge_u32 s2, 256
  s_cbranch_scc1 L_end
  s_load_dwordx16 s[16:31], s[0:1], 0
  s_load_dwordx8 s[32:39], s[0:1], 64
  s_load_dwordx4 s[40:43], s[0:1], 96
  v_and_b32 v1, 63, v0
  v_lshrrev_b32 v6, 6, v0
  s_mov_b32 s14, 0xff
  v_readfirstlane_b32 s5, v6
  s_cmp_ge_u32 s2, 192
  s_cbranch_scc1 L_S
  s_and_b32 s3, s2, 7
  s_lshl_b32 s3, s3, 1
  s_lshr_b32 s4, s2, 3
  s_cmp_ge_u32 s4, 12
  s_cselect_b32 s8, 12, 0
  s_addc_u32 s3, s3, 0
  s_sub_u32 s4, s4, s8
  s_mul_i32 s99, s4, 21846
  s_lshr_b32 s99, s99, 16
  s_mul_i32 s9, s99, 3
  s_sub_u32 s9, s4, s9
  s_lshl_b32 s8, s99, 6
  s_cmp_eq_u32 s9, 0
  s_cselect_b32 s10, 4, 5
  s_cselect_b32 s11, 3, 2
  s_cselect_b32 s98, 1, 0
  s_cmp_eq_u32 s9, 1
  s_cselect_b32 s97, 19, 0
  s_add_u32 s8, s8, s97
  s_cmp_eq_u32 s9, 2
  s_cselect_b32 s97, 41, 0
  s_cselect_b32 s11, 3, s11
  s_add_u32 s8, s8, s97
  s_and_b32 s9, s5, 3
  s_mul_i32 s12, s9, s10
  s_min_u32 s13, s9, s11
  s_add_u32 s12, s12, s13
  s_cmp_lt_u32 s9, s11
  s_cselect_b32 s97, 1, 0
  s_add_u32 s97, s97, s10
  s_add_u32 s8, s8, s12
  s_lshl_b32 s15, s12, 7
  s_lshl_b32 s8, s8, 12
  s_lshl_b32 s9, s3, 24
  s_add_u32 s8, s8, s9
  s_add_u32 s8, s8, 15728640
  s_lshl_b32 s9, s3, 2
  s_add_u32 s99, s99, s9
  s_cmp_lt_u32 s99, 54
  s_cselect_b32 s98, s98, 0
  v_and_b32 v6, 15, v1
  v_lshrrev_b32 v7, 4, v1
  v_lshlrev_b32 v8, 2, v7
  v_xor_b32 v8, v8, v6
  v_lshlrev_b32 v9, 8, v7
  v_add_u32 v9, s8, v9
  v_lshl_add_u32 v220, v8, 4, v9
  v_xor_b32 v10, 1, v8
  v_lshl_add_u32 v221, v10, 4, v9
  v_xor_b32 v10, 2, v8
  v_lshl_add_u32 v222, v10, 4, v9
  v_xor_b32 v10, 3, v8
  v_lshl_add_u32 v223, v10, 4, v9
  v_lshlrev_b32 v8, 4, v1
  v_add_u32 v209, s8, v8
  s_waitcnt lgkmcnt(0)
  s_add_u32 s27, s15, 21504
  s_and_b32 s26, s5, 3
  s_mul_i32 s26, s26, 24576
  s_add_u32 s26, s26, 43008
  s_load_dword s7, s[42:43], 0
  s_cmp_eq_u32 s98, 0
  s_cbranch_scc1 Lnm_1
  s_mul_i32 s62, s99, 3641
  s_lshr_b32 s62, s62, 16
  s_mul_i32 s8, s62, 18
  s_sub_u32 s63, s99, s8
  s_mul_i32 s8, s62, 1327104
  s_lshl_b32 s9, s63, 7
  s_add_u32 s8, s8, s9
  v_lshrrev_b32 v6, 3, v1
  s_lshl_b32 s11, s5, 3
  v_add_u32 v6, s11, v6
  v_mul_u32_u24 v6, 6912, v6
  v_and_b32 v7, 7, v1
  v_lshlrev_b32 v7, 4, v7
  v_add3_u32 v12, v6, v7, s8
  v_lshrrev_b32 v8, 3, v1
  s_lshl_b32 s11, s5, 3
  v_add_u32 v8, s11, v8
  v_lshlrev_b32 v8, 1, v8
  s_mul_i32 s11, s62, 384
  s_mov_b32 s52, s36
  s_mov_b32 s53, s37
  s_mov_b32 s54, 0x3cc000
  s_mov_b32 s55, 0x00020000
  s_mov_b32 s56, s34
  s_mov_b32 s57, s35
  s_mov_b32 s58, 0x480
  s_mov_b32 s59, 0x00020000
  v_add_u32 v6, 0, v12
  buffer_load_dwordx4 v[64:67], v6, s[52:55], 0 offen nt
  v_add_u32 v6, 442368, v12
  buffer_load_dwordx4 v[68:71], v6, s[52:55], 0 offen nt
  v_add_u32 v6, 884736, v12
  buffer_load_dwordx4 v[72:75], v6, s[52:55], 0 offen nt
  buffer_load_ushort v112, v8, s[56:59], s11 offen offset:0
  buffer_load_ushort v113, v8, s[56:59], s11 offen offset:128
  buffer_load_ushort v114, v8, s[56:59], s11 offen offset:256
  s_branch Lfd_2
Lnm_1:
Lfd_2:
  s_mov_b32 s44, s42
  s_mov_b32 s45, s43
  s_mov_b32 s46, 0x400000
  s_mov_b32 s47, 0x00020000
  v_lshlrev_b32 v13, 4, v0
  v_and_b32 v6, 7, v0
  v_bfe_u32 v7, v0, 3, 1
  v_lshrrev_b32 v8, 4, v0
  v_mul_u32_u24 v15, 400, v6
  v_mul_u32_u24 v9, 192, v7
  v_lshlrev_b32 v10, 2, v8
  v_add3_u32 v15, v15, v9, v10
  v_lshlrev_b32 v11, 7, v8
  v_lshlrev_b32 v9, 6, v7
  v_lshlrev_b32 v10, 1, v6
  v_add3_u32 v11, v11, v9, v10
  v_and_b32 v6, 1, v1
  v_mov_b32 v7, 0xffff0000
  v_mov_b32 v8, 0xffff
  v_cmp_eq_u32 vcc, 1, v6
  v_bfe_u32 v6, v1, 1, 2
  s_nop 0
  v_cndmask_b32 v9, v8, v7, vcc
  v_cmp_eq_u32 vcc, 0, v6
  s_nop 1
  v_cndmask_b32 v2, 0, v9, vcc
  v_cmp_eq_u32 vcc, 1, v6
  s_nop 1
  v_cndmask_b32 v3, 0, v9, vcc
  v_cmp_eq_u32 vcc, 2, v6
  s_nop 1
  v_cndmask_b32 v4, 0, v9, vcc
  v_cmp_eq_u32 vcc, 3, v6
  s_nop 1
  v_cndmask_b32 v5, 0, v9, vcc
  v_and_b32 v6, 7, v1
  v_bfe_u32 v7, v1, 4, 1
  v_lshl_add_u32 v6, v7, 3, v6
  v_lshlrev_b32 v6, 4, v6
  s_lshl_b32 s8, s5, 8
  v_add_u32 v240, s8, v6
  v_lshrrev_b32 v6, 3, v1
  v_mul_u32_u24 v6, 400, v6
  s_mul_i32 s8, s5, 48
  v_add_u32 v241, s8, v6
  v_lshlrev_b32 v242, 4, v1
  s_cmp_lg_u32 s5, 0
  s_cbranch_scc1 Lz_3
  v_mov_b32 v6, 7008
  v_mov_b32 v16, 0
  v_mov_b32 v17, 0
  v_mov_b32 v18, 0
  v_mov_b32 v19, 0
  s_mov_b64 exec, 1
  ds_write_b128 v6, v[16:19]
  ds_write_b128 v6, v[16:19] offset:16
  ds_write_b64 v6, v[16:17] offset:40
  ds_write_b32 v6, v16 offset:36
  s_mov_b64 exec, -1
Lz_3:
  s_cmp_eq_u32 s98, 0
  s_cbranch_scc1 Lnm_4
  v_lshrrev_b32 v10, 4, v1
  v_min_u32 v10, 0, v10
  v_lshlrev_b32 v10, 11, v10
  v_and_b32 v6, 15, v1
  v_lshl_add_u32 v10, v6, 4, v10
  s_mul_i32 s8, s62, 4608
  s_lshl_b32 s9, s63, 8
  s_add_u32 s8, s8, s9
  s_add_u32 s8, s8, 0x1000
  v_add_u32 v9, s8, v242
  s_waitcnt vmcnt(0)
  v_lshlrev_b32 v112, 16, v112
  v_lshlrev_b32 v113, 16, v113
  v_lshlrev_b32 v114, 16, v114
  v_mul_f32 v6, 0xbfb8aa3b, v112
  v_mul_f32 v7, 0xbfb8aa3b, v113
  v_mul_f32 v8, 0xbfb8aa3b, v114
  v_exp_f32 v6, v6
  v_exp_f32 v7, v7
  v_exp_f32 v8, v8
  v_add_f32 v6, 1.0, v6
  v_add_f32 v7, 1.0, v7
  v_add_f32 v8, 1.0, v8
  v_rcp_f32 v6, v6
  v_rcp_f32 v7, v7
  v_rcp_f32 v8, v8
  v_mul_f32 v112, v112, v6
  v_mul_f32 v113, v113, v7
  v_mul_f32 v114, v114, v8
  v_cvt_pk_bf16_f32 v112, v112, v112
  v_cvt_pk_bf16_f32 v113, v113, v113
  v_cvt_pk_bf16_f32 v114, v114, v114
  v_and_b32 v116, v112, v2
  v_and_b32 v117, v112, v3
  v_and_b32 v118, v112, v4
  v_and_b32 v119, v112, v5
  v_and_b32 v120, v113, v2
  v_and_b32 v121, v113, v3
  v_and_b32 v122, v113, v4
  v_and_b32 v123, v113, v5
  v_mfma_f32_16x16x32_bf16 v[188:191], v[64:67], v[116:119], 0
  v_and_b32 v116, v114, v2
  v_and_b32 v117, v114, v3
  v_and_b32 v118, v114, v4
  v_and_b32 v119, v114, v5
  v_mfma_f32_16x16x32_bf16 v[188:191], v[68:71], v[120:123], v[188:191]
  s_nop 0
  v_mfma_f32_16x16x32_bf16 v[188:191], v[72:75], v[116:119], v[188:191]
  s_nop 7
  v_mov_b32 v116, v188
  v_mov_b32 v117, v189
  v_mov_b32 v118, v190
  v_mov_b32 v119, v191
  v_permlane32_swap_b32 v116, v188
  v_permlane32_swap_b32 v117, v189
  v_permlane32_swap_b32 v118, v190
  v_permlane32_swap_b32 v119, v191
  v_add_f32_dpp v188, v188, v116 row_ror:8 row_mask:0xf bank_mask:0xf
  v_add_f32_dpp v189, v189, v117 row_ror:8 row_mask:0xf bank_mask:0xf
  v_add_f32_dpp v190, v190, v118 row_ror:8 row_mask:0xf bank_mask:0xf
  v_add_f32_dpp v191, v191, v119 row_ror:8 row_mask:0xf bank_mask:0xf
  s_mov_b32 exec_lo, 0xff00ff
  s_mov_b32 exec_hi, 0x0
  ds_write_b128 v240, v[188:191] offset:7168
  s_mov_b64 exec, -1
  s_waitcnt lgkmcnt(0)
  s_add_u32 s6, s7, 1
  s_and_b32 s6, s6, 0xff
  v_mov_b32 v14, s6
  s_barrier
  s_cmp_lg_u32 s5, 7
  s_cbranch_scc1 Lmp_6
  ds_read_b128 v[128:131], v10 offset:7168
  ds_read_b128 v[132:135], v10 offset:7424
  ds_read_b128 v[136:139], v10 offset:7680
  ds_read_b128 v[140:143], v10 offset:7936
  ds_read_b128 v[144:147], v10 offset:8192
  ds_read_b128 v[148:151], v10 offset:8448
  ds_read_b128 v[152:155], v10 offset:8704
  ds_read_b128 v[156:159], v10 offset:8960
  s_waitcnt lgkmcnt(0)
  v_pk_add_f32 v[128:129], v[128:129], v[132:133]
  v_pk_add_f32 v[130:131], v[130:131], v[134:135]
  v_pk_add_f32 v[136:137], v[136:137], v[140:141]
  v_pk_add_f32 v[138:139], v[138:139], v[142:143]
  v_pk_add_f32 v[144:145], v[144:145], v[148:149]
  v_pk_add_f32 v[146:147], v[146:147], v[150:151]
  v_pk_add_f32 v[152:153], v[152:153], v[156:157]
  v_pk_add_f32 v[154:155], v[154:155], v[158:159]
  v_pk_add_f32 v[128:129], v[128:129], v[136:137]
  v_pk_add_f32 v[130:131], v[130:131], v[138:139]
  v_pk_add_f32 v[144:145], v[144:145], v[152:153]
  v_pk_add_f32 v[146:147], v[146:147], v[154:155]
  v_pk_add_f32 v[128:129], v[128:129], v[144:145]
  v_pk_add_f32 v[130:131], v[130:131], v[146:147]
  v_bfi_b32 v128, s14, v14, v128
  v_bfi_b32 v129, s14, v14, v129
  v_bfi_b32 v130, s14, v14, v130
  v_bfi_b32 v131, s14, v14, v131
  s_mov_b32 exec_lo, 0xffff
  s_mov_b32 exec_hi, 0x0
  buffer_store_dwordx4 v[128:131], v9, s[44:47], 0 offen offset:0 sc1
  s_mov_b64 exec, -1
Lmp_6:
  s_barrier
  s_branch Lj2_5
Lnm_4:
  s_waitcnt vmcnt(0) lgkmcnt(0)
  s_barrier
Lj2_5:
  v_mov_b32 v204, 0
  v_mov_b32 v205, 0
  v_mov_b32 v206, 0
  v_mov_b32 v207, 0
  s_cmp_ge_u32 s5, 4
  s_cbranch_scc1 L_FV
  s_cmp_ge_u32 s5, 3
  s_cbranch_scc1 Lfx_7
  s_mov_b32 s56, s16
  s_mov_b32 s57, s17
  s_mov_b32 s58, 0x480
  s_mov_b32 s59, 0x00020000
  s_mov_b64 exec, -1
  s_cmp_lg_u32 s5, 2
  s_cbranch_scc1 Lx_8
  s_mov_b32 exec_lo, 0xffff
  s_mov_b32 exec_hi, 0x0
Lx_8:
  buffer_load_ushort v204, v11, s[56:59], 0 offen offset:0
  buffer_load_ushort v205, v11, s[56:59], 0 offen offset:16
  buffer_load_ushort v206, v11, s[56:59], 0 offen offset:32
  buffer_load_ushort v207, v11, s[56:59], 0 offen offset:48
  s_mov_b64 exec, -1
Lfx_7:
  s_cmp_lg_u32 s5, 0
  s_cbranch_scc1 Lfa_9
  s_getreg_b32 s96, hwreg(HW_REG_XCC_ID, 0, 4)
  s_and_b32 s96, s96, 7
  s_lshl_b32 s9, s96, 5
  v_mov_b32 v210, s9
  v_mov_b32 v211, 1
  s_mov_b64 exec, 1
  global_atomic_add v211, v210, v211, s[40:41] sc0 sc1
  s_mov_b64 exec, -1
Lfa_9:
  s_mov_b32 s48, s18
  s_mov_b32 s49, s19
  s_mov_b32 s50, 0x10000000
  s_mov_b32 s51, 0x00020000
  s_mov_b32 s8, 0
  s_add_u32 m0, s26, 0
  s_nop 0
  buffer_load_dwordx4 v220, s[48:51], s8 offen offset:0 nt lds
  s_add_u32 m0, s26, 0
  s_nop 0
  buffer_load_dwordx4 v221, s[48:51], s8 offen offset:1024 nt lds
  s_add_u32 m0, s26, 0
  s_nop 0
  buffer_load_dwordx4 v222, s[48:51], s8 offen offset:2048 nt lds
  s_waitcnt vmcnt(2)
  s_add_u32 m0, s26, 0
  s_nop 0
  buffer_load_dwordx4 v223, s[48:51], s8 offen offset:3072 nt lds
  s_mov_b32 s8, 4096
  s_waitcnt vmcnt(2)
  s_add_u32 m0, s26, 4096
  s_nop 0
  buffer_load_dwordx4 v220, s[48:51], s8 offen offset:0 nt lds
  s_waitcnt vmcnt(2)
  s_add_u32 m0, s26, 4096
  s_nop 0
  buffer_load_dwordx4 v221, s[48:51], s8 offen offset:1024 nt lds
  s_waitcnt vmcnt(2)
  s_add_u32 m0, s26, 4096
  s_nop 0
  buffer_load_dwordx4 v222, s[48:51], s8 offen offset:2048 nt lds
  s_waitcnt vmcnt(2)
  s_add_u32 m0, s26, 4096
  s_nop 0
  buffer_load_dwordx4 v223, s[48:51], s8 offen offset:3072 nt lds
  s_mov_b32 s8, 8192
  s_waitcnt vmcnt(2)
  s_add_u32 m0, s26, 8192
  s_nop 0
  buffer_load_dwordx4 v220, s[48:51], s8 offen offset:0 nt lds
  s_add_u32 m0, s26, 8192
  s_nop 0
  buffer_load_dwordx4 v221, s[48:51], s8 offen offset:1024 nt lds
  s_add_u32 m0, s26, 8192
  s_nop 0
  buffer_load_dwordx4 v222, s[48:51], s8 offen offset:2048 nt lds
  s_add_u32 m0, s26, 8192
  s_nop 0
  buffer_load_dwordx4 v223, s[48:51], s8 offen offset:3072 nt lds
  s_mov_b32 s8, 12288
  s_add_u32 m0, s26, 12288
  s_nop 0
  buffer_load_dwordx4 v220, s[48:51], s8 offen offset:0 nt lds
  s_add_u32 m0, s26, 12288
  s_nop 0
  buffer_load_dwordx4 v221, s[48:51], s8 offen offset:1024 nt lds
  s_add_u32 m0, s26, 12288
  s_nop 0
  buffer_load_dwordx4 v222, s[48:51], s8 offen offset:2048 nt lds
  s_add_u32 m0, s26, 12288
  s_nop 0
  buffer_load_dwordx4 v223, s[48:51], s8 offen offset:3072 nt lds
  s_cmp_le_u32 s97, 4
  s_cbranch_scc1 Lkend_10
  s_mov_b32 s8, 16384
  s_add_u32 m0, s26, 16384
  s_nop 0
  buffer_load_dwordx4 v220, s[48:51], s8 offen offset:0 nt lds
  s_add_u32 m0, s26, 16384
  s_nop 0
  buffer_load_dwordx4 v221, s[48:51], s8 offen offset:1024 nt lds
  s_add_u32 m0, s26, 16384
  s_nop 0
  buffer_load_dwordx4 v222, s[48:51], s8 offen offset:2048 nt lds
  s_add_u32 m0, s26, 16384
  s_nop 0
  buffer_load_dwordx4 v223, s[48:51], s8 offen offset:3072 nt lds
  s_cmp_le_u32 s97, 5
  s_cbranch_scc1 Lkend_10
  s_mov_b32 s8, 20480
  s_add_u32 m0, s26, 20480
  s_nop 0
  buffer_load_dwordx4 v220, s[48:51], s8 offen offset:0 nt lds
  s_add_u32 m0, s26, 20480
  s_nop 0
  buffer_load_dwordx4 v221, s[48:51], s8 offen offset:1024 nt lds
  s_add_u32 m0, s26, 20480
  s_nop 0
  buffer_load_dwordx4 v222, s[48:51], s8 offen offset:2048 nt lds
  s_add_u32 m0, s26, 20480
  s_nop 0
  buffer_load_dwordx4 v223, s[48:51], s8 offen offset:3072 nt lds
Lkend_10:
  v_mov_b32 v6, 7044
  v_mov_b32 v7, 1
  s_mov_b64 exec, 1
  ds_add_u32 v6, v7
  s_mov_b64 exec, -1
  s_cmp_lg_u32 s5, 0
  s_cbranch_scc1 Lsl_11
  s_waitcnt vmcnt(16)
  v_readfirstlane_b32 s8, v211
  s_nop 0
  s_cmp_lt_u32 s8, 24
  s_cbranch_scc1 Lslok_12
  v_mov_b32 v210, 4
  v_mov_b32 v211, 1
  s_mov_b64 exec, 1
  global_atomic_add v211, v210, v211, s[40:41] sc0 sc1
  s_mov_b32 exec_lo, 0xff
  s_mov_b32 exec_hi, 0
  v_lshlrev_b32 v210, 5, v1
  s_waitcnt vmcnt(0)
  v_readfirstlane_b32 s9, v211
  s_mov_b32 s15, 0
Lsllp_13:
  global_load_dword v212, v210, s[40:41] sc1
  s_waitcnt vmcnt(0)
  s_mov_b32 s10, 0
  v_readlane_b32 s11, v212, 0
  s_nop 0
  s_add_u32 s10, s10, s11
  v_readlane_b32 s11, v212, 1
  s_nop 0
  s_add_u32 s10, s10, s11
  v_readlane_b32 s11, v212, 2
  s_nop 0
  s_add_u32 s10, s10, s11
  v_readlane_b32 s11, v212, 3
  s_nop 0
  s_add_u32 s10, s10, s11
  v_readlane_b32 s11, v212, 4
  s_nop 0
  s_add_u32 s10, s10, s11
  v_readlane_b32 s11, v212, 5
  s_nop 0
  s_add_u32 s10, s10, s11
  v_readlane_b32 s11, v212, 6
  s_nop 0
  s_add_u32 s10, s10, s11
  v_readlane_b32 s11, v212, 7
  s_nop 0
  s_add_u32 s10, s10, s11
  s_add_u32 s15, s15, 1
  s_cmp_ge_u32 s10, 192
  s_cbranch_scc1 Lsl2_14
  s_cmp_lt_u32 s15, 20000
  s_cbranch_scc1 Lsllp_13
Lsl2_14:
  s_mov_b32 s96, 0
  v_readlane_b32 s11, v212, 0
  s_nop 0
  s_min_u32 s11, s11, 24
  s_sub_u32 s10, 24, s11
  s_cmp_ge_u32 s9, s10
  s_cbranch_scc1 Lnx_16
  s_add_u32 s96, s11, s9
  s_add_u32 s96, s96, 0
  s_branch Lslf_15
Lnx_16:
  s_sub_u32 s9, s9, s10
  v_readlane_b32 s11, v212, 1
  s_nop 0
  s_min_u32 s11, s11, 24
  s_sub_u32 s10, 24, s11
  s_cmp_ge_u32 s9, s10
  s_cbranch_scc1 Lnx_17
  s_add_u32 s96, s11, s9
  s_add_u32 s96, s96, 24
  s_branch Lslf_15
Lnx_17:
  s_sub_u32 s9, s9, s10
  v_readlane_b32 s11, v212, 2
  s_nop 0
  s_min_u32 s11, s11, 24
  s_sub_u32 s10, 24, s11
  s_cmp_ge_u32 s9, s10
  s_cbranch_scc1 Lnx_18
  s_add_u32 s96, s11, s9
  s_add_u32 s96, s96, 48
  s_branch Lslf_15
Lnx_18:
  s_sub_u32 s9, s9, s10
  v_readlane_b32 s11, v212, 3
  s_nop 0
  s_min_u32 s11, s11, 24
  s_sub_u32 s10, 24, s11
  s_cmp_ge_u32 s9, s10
  s_cbranch_scc1 Lnx_19
  s_add_u32 s96, s11, s9
  s_add_u32 s96, s96, 72
  s_branch Lslf_15
Lnx_19:
  s_sub_u32 s9, s9, s10
  v_readlane_b32 s11, v212, 4
  s_nop 0
  s_min_u32 s11, s11, 24
  s_sub_u32 s10, 24, s11
  s_cmp_ge_u32 s9, s10
  s_cbranch_scc1 Lnx_20
  s_add_u32 s96, s11, s9
  s_add_u32 s96, s96, 96
  s_branch Lslf_15
Lnx_20:
  s_sub_u32 s9, s9, s10
  v_readlane_b32 s11, v212, 5
  s_nop 0
  s_min_u32 s11, s11, 24
  s_sub_u32 s10, 24, s11
  s_cmp_ge_u32 s9, s10
  s_cbranch_scc1 Lnx_21
  s_add_u32 s96, s11, s9
  s_add_u32 s96, s96, 120
  s_branch Lslf_15
Lnx_21:
  s_sub_u32 s9, s9, s10
  v_readlane_b32 s11, v212, 6
  s_nop 0
  s_min_u32 s11, s11, 24
  s_sub_u32 s10, 24, s11
  s_cmp_ge_u32 s9, s10
  s_cbranch_scc1 Lnx_22
  s_add_u32 s96, s11, s9
  s_add_u32 s96, s96, 144
  s_branch Lslf_15
Lnx_22:
  s_sub_u32 s9, s9, s10
  v_readlane_b32 s11, v212, 7
  s_nop 0
  s_min_u32 s11, s11, 24
  s_sub_u32 s10, 24, s11
  s_cmp_ge_u32 s9, s10
  s_cbranch_scc1 Lnx_23
  s_add_u32 s96, s11, s9
  s_add_u32 s96, s96, 168
  s_branch Lslf_15
Lnx_23:
  s_sub_u32 s9, s9, s10
  s_branch Lslf_15
Lslok_12:
  s_mul_i32 s96, s96, 24
  s_add_u32 s96, s96, s8
Lslf_15:
  s_mov_b64 exec, -1
  s_min_u32 s96, s96, 191
  v_mov_b32 v210, 7040
  v_mov_b32 v211, s96
  ds_write_b32 v210, v211
Lsl_11:
  s_waitcnt lgkmcnt(0)
  s_add_u32 s6, s7, 1
  s_and_b32 s6, s6, 0xff
  v_mov_b32 v14, s6
  v_and_b32 v6, 15, v1
  v_lshrrev_b32 v7, 4, v1
  v_and_b32 v8, 3, v6
  v_lshlrev_b32 v8, 10, v8
  v_lshrrev_b32 v9, 2, v6
  v_lshlrev_b32 v9, 8, v9
  v_add3_u32 v8, v8, v9, s26
  v_xor_b32 v7, v7, v6
  v_xor_b32 v9, 0, v7
  v_lshl_add_u32 v220, v9, 4, v8
  v_xor_b32 v9, 4, v7
  v_lshl_add_u32 v221, v9, 4, v8
  v_xor_b32 v9, 8, v7
  v_lshl_add_u32 v222, v9, 4, v8
  v_xor_b32 v9, 12, v7
  v_lshl_add_u32 v223, v9, 4, v8
  s_lshl_b32 s8, s3, 10
  s_lshl_b32 s9, s5, 8
  s_add_u32 s8, s8, s9
  s_add_u32 s8, s8, 0x10000
  s_add_u32 s12, s42, s8
  s_addc_u32 s13, s43, 0
  s_mov_b32 s15, 0
  v_and_b32 v6, 3, v1
  v_lshlrev_b32 v6, 4, v6
  v_bfe_u32 v7, v1, 2, 3
  v_lshlrev_b32 v7, 1, v7
  v_lshrrev_b32 v8, 5, v1
  v_lshlrev_b32 v8, 6, v8
  s_lshl_b32 s9, s5, 7
  s_add_u32 s9, s9, 6400
  v_add3_u32 v8, v6, v7, v8
  v_add_u32 v8, s9, v8
  v_bfe_u32 v6, v1, 3, 1
  v_lshrrev_b32 v7, 4, v1
  v_lshlrev_b32 v6, 8, v6
  v_lshlrev_b32 v7, 4, v7
  v_add_u32 v9, v6, v7
  v_add_u32 v9, 6400, v9
  v_mov_b32 v10, 7008
  v_lshrrev_b32 v12, 4, v1
  v_lshlrev_b32 v12, 5, v12
  v_bfe_u32 v7, v1, 3, 1
  v_lshlrev_b32 v7, 4, v7
  v_add3_u32 v213, v12, v7, s27
Lq_24:
  s_load_dwordx16 s[48:63], s[12:13], 0 glc
  s_load_dwordx16 s[64:79], s[12:13], 64 glc
  s_load_dwordx16 s[80:95], s[12:13], 128 glc
  s_load_dwordx16 s[16:31], s[12:13], 192 glc
  s_add_u32 s15, s15, 1
  s_waitcnt lgkmcnt(0)
  s_xor_b32 s8, s48, s6
  s_xor_b32 s9, s31, s6
  s_or_b32 s8, s8, s9
  s_and_b32 s8, s8, 0xff
  s_cmp_lg_u32 s8, 0
  s_cbranch_scc1 Lqr_26
  v_writelane_b32 v6, s48, 0
  v_writelane_b32 v6, s49, 1
  v_writelane_b32 v6, s50, 2
  v_writelane_b32 v6, s51, 3
  v_writelane_b32 v6, s52, 4
  v_writelane_b32 v6, s53, 5
  v_writelane_b32 v6, s54, 6
  v_writelane_b32 v6, s55, 7
  v_writelane_b32 v6, s56, 8
  v_writelane_b32 v6, s57, 9
  v_writelane_b32 v6, s58, 10
  v_writelane_b32 v6, s59, 11
  v_writelane_b32 v6, s60, 12
  v_writelane_b32 v6, s61, 13
  v_writelane_b32 v6, s62, 14
  v_writelane_b32 v6, s63, 15
  v_writelane_b32 v6, s64, 16
  v_writelane_b32 v6, s65, 17
  v_writelane_b32 v6, s66, 18
  v_writelane_b32 v6, s67, 19
  v_writelane_b32 v6, s68, 20
  v_writelane_b32 v6, s69, 21
  v_writelane_b32 v6, s70, 22
  v_writelane_b32 v6, s71, 23
  v_writelane_b32 v6, s72, 24
  v_writelane_b32 v6, s73, 25
  v_writelane_b32 v6, s74, 26
  v_writelane_b32 v6, s75, 27
  v_writelane_b32 v6, s76, 28
  v_writelane_b32 v6, s77, 29
  v_writelane_b32 v6, s78, 30
  v_writelane_b32 v6, s79, 31
  v_writelane_b32 v6, s80, 32
  v_writelane_b32 v6, s81, 33
  v_writelane_b32 v6, s82, 34
  v_writelane_b32 v6, s83, 35
  v_writelane_b32 v6, s84, 36
  v_writelane_b32 v6, s85, 37
  v_writelane_b32 v6, s86, 38
  v_writelane_b32 v6, s87, 39
  v_writelane_b32 v6, s88, 40
  v_writelane_b32 v6, s89, 41
  v_writelane_b32 v6, s90, 42
  v_writelane_b32 v6, s91, 43
  v_writelane_b32 v6, s92, 44
  v_writelane_b32 v6, s93, 45
  v_writelane_b32 v6, s94, 46
  v_writelane_b32 v6, s95, 47
  v_writelane_b32 v6, s16, 48
  v_writelane_b32 v6, s17, 49
  v_writelane_b32 v6, s18, 50
  v_writelane_b32 v6, s19, 51
  v_writelane_b32 v6, s20, 52
  v_writelane_b32 v6, s21, 53
  v_writelane_b32 v6, s22, 54
  v_writelane_b32 v6, s23, 55
  v_writelane_b32 v6, s24, 56
  v_writelane_b32 v6, s25, 57
  v_writelane_b32 v6, s26, 58
  v_writelane_b32 v6, s27, 59
  v_writelane_b32 v6, s28, 60
  v_writelane_b32 v6, s29, 61
  v_writelane_b32 v6, s30, 62
  v_writelane_b32 v6, s31, 63
  v_xor_b32 v7, v6, v14
  v_and_b32 v7, 0xff, v7
  v_cmp_ne_u32 vcc, 0, v7
  s_nop 0
  s_cbranch_vccz Lqok_25
Lqr_26:
  s_cmp_lt_u32 s15, 20000
  s_cbranch_scc1 Lq_24
Lqok_25:
  ds_write_b16_d16_hi v8, v6
  s_load_dwordx4 s[28:31], s[0:1], 48
  s_waitcnt lgkmcnt(0)
  v_mov_b32 v6, 7008
  v_mov_b32 v7, 1
  s_mov_b64 exec, 1
  ds_add_u32 v6, v7
  s_mov_b64 exec, -1
  s_waitcnt vmcnt(0)
  ds_read_b128 v[16:19], v220
  ds_read_b128 v[20:23], v221
  ds_read_b128 v[24:27], v222
  ds_read_b128 v[28:31], v223
  s_mov_b32 s15, 0
Lsp_27:
  ds_read_b32 v7, v10
  s_add_u32 s15, s15, 1
  s_waitcnt lgkmcnt(0)
  v_readfirstlane_b32 s8, v7
  s_nop 0
  s_cmp_ge_u32 s8, 4
  s_cbranch_scc1 Lspo_28
  s_cmp_lt_u32 s15, 160000
  s_cbranch_scc1 Lsp_27
Lspo_28:
  ds_read_b128 v[48:51], v9 offset:0
  ds_read_b128 v[52:55], v9 offset:64
  ds_read_b128 v[56:59], v9 offset:128
  ds_read_b128 v[60:63], v9 offset:192
  v_mov_b32 v80, 0xff800000
  v_mov_b32 v81, 0xff800000
  v_mov_b32 v82, 0xff800000
  v_mov_b32 v83, 0xff800000
  v_mov_b32 v84, 0xff800000
  v_mov_b32 v85, 0xff800000
  v_mov_b32 v86, 0xff800000
  v_mov_b32 v87, 0xff800000
  ds_read_b128 v[32:35], v220 offset:4096
  ds_read_b128 v[36:39], v221 offset:4096
  ds_read_b128 v[40:43], v222 offset:4096
  ds_read_b128 v[44:47], v223 offset:4096
  s_waitcnt lgkmcnt(4)
  v_mfma_f32_16x16x32_bf16 v[64:67], v[16:19], v[48:51], 0
  v_mfma_f32_16x16x32_bf16 v[64:67], v[20:23], v[52:55], v[64:67]
  v_mfma_f32_16x16x32_bf16 v[64:67], v[24:27], v[56:59], v[64:67]
  v_mfma_f32_16x16x32_bf16 v[64:67], v[28:31], v[60:63], v[64:67]
  ds_read_b128 v[16:19], v220 offset:8192
  ds_read_b128 v[20:23], v221 offset:8192
  ds_read_b128 v[24:27], v222 offset:8192
  ds_read_b128 v[28:31], v223 offset:8192
  s_waitcnt lgkmcnt(4)
  v_mfma_f32_16x16x32_bf16 v[68:71], v[32:35], v[48:51], 0
  v_mfma_f32_16x16x32_bf16 v[68:71], v[36:39], v[52:55], v[68:71]
  v_mfma_f32_16x16x32_bf16 v[68:71], v[40:43], v[56:59], v[68:71]
  v_mfma_f32_16x16x32_bf16 v[68:71], v[44:47], v[60:63], v[68:71]
  ds_read_b128 v[32:35], v220 offset:12288
  ds_read_b128 v[36:39], v221 offset:12288
  ds_read_b128 v[40:43], v222 offset:12288
  ds_read_b128 v[44:47], v223 offset:12288
  s_waitcnt lgkmcnt(4)
  v_mfma_f32_16x16x32_bf16 v[72:75], v[16:19], v[48:51], 0
  v_mfma_f32_16x16x32_bf16 v[72:75], v[20:23], v[52:55], v[72:75]
  v_mfma_f32_16x16x32_bf16 v[72:75], v[24:27], v[56:59], v[72:75]
  v_mfma_f32_16x16x32_bf16 v[72:75], v[28:31], v[60:63], v[72:75]
  ds_read_b128 v[16:19], v220 offset:16384
  ds_read_b128 v[20:23], v221 offset:16384
  ds_read_b128 v[24:27], v222 offset:16384
  ds_read_b128 v[28:31], v223 offset:16384
  s_waitcnt lgkmcnt(4)
  v_mfma_f32_16x16x32_bf16 v[76:79], v[32:35], v[48:51], 0
  v_mfma_f32_16x16x32_bf16 v[76:79], v[36:39], v[52:55], v[76:79]
  v_mfma_f32_16x16x32_bf16 v[76:79], v[40:43], v[56:59], v[76:79]
  v_mfma_f32_16x16x32_bf16 v[76:79], v[44:47], v[60:63], v[76:79]
  s_cmp_le_u32 s97, 4
  s_cbranch_scc1 Lqe_29
  ds_read_b128 v[32:35], v220 offset:20480
  ds_read_b128 v[36:39], v221 offset:20480
  ds_read_b128 v[40:43], v222 offset:20480
  ds_read_b128 v[44:47], v223 offset:20480
  s_waitcnt lgkmcnt(4)
  v_mfma_f32_16x16x32_bf16 v[80:83], v[16:19], v[48:51], 0
  v_mfma_f32_16x16x32_bf16 v[80:83], v[20:23], v[52:55], v[80:83]
  v_mfma_f32_16x16x32_bf16 v[80:83], v[24:27], v[56:59], v[80:83]
  v_mfma_f32_16x16x32_bf16 v[80:83], v[28:31], v[60:63], v[80:83]
  s_cmp_le_u32 s97, 5
  s_cbranch_scc1 Lqe_29
  s_waitcnt lgkmcnt(0)
  v_mfma_f32_16x16x32_bf16 v[84:87], v[32:35], v[48:51], 0
  v_mfma_f32_16x16x32_bf16 v[84:87], v[36:39], v[52:55], v[84:87]
  v_mfma_f32_16x16x32_bf16 v[84:87], v[40:43], v[56:59], v[84:87]
  v_mfma_f32_16x16x32_bf16 v[84:87], v[44:47], v[60:63], v[84:87]
Lqe_29:
  s_waitcnt lgkmcnt(0)
  s_nop 7
  s_mov_b32 s8, 0x3db504f3
  s_mov_b32 s10, 0x3fb8aa3b
  v_cvt_pk_bf16_f32 v6, v64, v65
  v_lshlrev_b32 v64, 16, v6
  v_and_b32 v65, 0xffff0000, v6
  v_mul_f32 v64, s8, v64
  v_mul_f32 v65, s8, v65
  v_cvt_pk_bf16_f32 v6, v64, v65
  v_lshlrev_b32 v64, 16, v6
  v_and_b32 v65, 0xffff0000, v6
  v_cvt_pk_bf16_f32 v7, v66, v67
  v_lshlrev_b32 v66, 16, v7
  v_and_b32 v67, 0xffff0000, v7
  v_mul_f32 v66, s8, v66
  v_mul_f32 v67, s8, v67
  v_cvt_pk_bf16_f32 v7, v66, v67
  v_lshlrev_b32 v66, 16, v7
  v_and_b32 v67, 0xffff0000, v7
  v_cvt_pk_bf16_f32 v6, v68, v69
  v_lshlrev_b32 v68, 16, v6
  v_and_b32 v69, 0xffff0000, v6
  v_mul_f32 v68, s8, v68
  v_mul_f32 v69, s8, v69
  v_cvt_pk_bf16_f32 v6, v68, v69
  v_lshlrev_b32 v68, 16, v6
  v_and_b32 v69, 0xffff0000, v6
  v_cvt_pk_bf16_f32 v7, v70, v71
  v_lshlrev_b32 v70, 16, v7
  v_and_b32 v71, 0xffff0000, v7
  v_mul_f32 v70, s8, v70
  v_mul_f32 v71, s8, v71
  v_cvt_pk_bf16_f32 v7, v70, v71
  v_lshlrev_b32 v70, 16, v7
  v_and_b32 v71, 0xffff0000, v7
  v_cvt_pk_bf16_f32 v6, v72, v73
  v_lshlrev_b32 v72, 16, v6
  v_and_b32 v73, 0xffff0000, v6
  v_mul_f32 v72, s8, v72
  v_mul_f32 v73, s8, v73
  v_cvt_pk_bf16_f32 v6, v72, v73
  v_lshlrev_b32 v72, 16, v6
  v_and_b32 v73, 0xffff0000, v6
  v_cvt_pk_bf16_f32 v7, v74, v75
  v_lshlrev_b32 v74, 16, v7
  v_and_b32 v75, 0xffff0000, v7
  v_mul_f32 v74, s8, v74
  v_mul_f32 v75, s8, v75
  v_cvt_pk_bf16_f32 v7, v74, v75
  v_lshlrev_b32 v74, 16, v7
  v_and_b32 v75, 0xffff0000, v7
  v_cvt_pk_bf16_f32 v6, v76, v77
  v_lshlrev_b32 v76, 16, v6
  v_and_b32 v77, 0xffff0000, v6
  v_mul_f32 v76, s8, v76
  v_mul_f32 v77, s8, v77
  v_cvt_pk_bf16_f32 v6, v76, v77
  v_lshlrev_b32 v76, 16, v6
  v_and_b32 v77, 0xffff0000, v6
  v_cvt_pk_bf16_f32 v7, v78, v79
  v_lshlrev_b32 v78, 16, v7
  v_and_b32 v79, 0xffff0000, v7
  v_mul_f32 v78, s8, v78
  v_mul_f32 v79, s8, v79
  v_cvt_pk_bf16_f32 v7, v78, v79
  v_lshlrev_b32 v78, 16, v7
  v_and_b32 v79, 0xffff0000, v7
  v_cvt_pk_bf16_f32 v6, v80, v81
  v_lshlrev_b32 v80, 16, v6
  v_and_b32 v81, 0xffff0000, v6
  v_mul_f32 v80, s8, v80
  v_mul_f32 v81, s8, v81
  v_cvt_pk_bf16_f32 v6, v80, v81
  v_lshlrev_b32 v80, 16, v6
  v_and_b32 v81, 0xffff0000, v6
  v_cvt_pk_bf16_f32 v7, v82, v83
  v_lshlrev_b32 v82, 16, v7
  v_and_b32 v83, 0xffff0000, v7
  v_mul_f32 v82, s8, v82
  v_mul_f32 v83, s8, v83
  v_cvt_pk_bf16_f32 v7, v82, v83
  v_lshlrev_b32 v82, 16, v7
  v_and_b32 v83, 0xffff0000, v7
  v_cvt_pk_bf16_f32 v6, v84, v85
  v_lshlrev_b32 v84, 16, v6
  v_and_b32 v85, 0xffff0000, v6
  v_mul_f32 v84, s8, v84
  v_mul_f32 v85, s8, v85
  v_cvt_pk_bf16_f32 v6, v84, v85
  v_lshlrev_b32 v84, 16, v6
  v_and_b32 v85, 0xffff0000, v6
  v_cvt_pk_bf16_f32 v7, v86, v87
  v_lshlrev_b32 v86, 16, v7
  v_and_b32 v87, 0xffff0000, v7
  v_mul_f32 v86, s8, v86
  v_mul_f32 v87, s8, v87
  v_cvt_pk_bf16_f32 v7, v86, v87
  v_lshlrev_b32 v86, 16, v7
  v_and_b32 v87, 0xffff0000, v7
  v_max3_f32 v214, v64, v65, v66
  v_max3_f32 v214, v214, v67, v68
  v_max3_f32 v214, v214, v69, v70
  v_max3_f32 v214, v214, v71, v72
  v_max3_f32 v214, v214, v73, v74
  v_max3_f32 v214, v214, v75, v76
  v_max3_f32 v214, v214, v77, v78
  v_max3_f32 v214, v214, v79, v80
  v_max3_f32 v214, v214, v81, v82
  v_max3_f32 v214, v214, v83, v84
  v_max3_f32 v214, v214, v85, v86
  v_max_f32 v214, v214, v87
  v_mov_b32 v7, v214
  s_nop 1
  v_permlane32_swap_b32 v7, v214
  v_max_f32 v214, v214, v7
  v_mov_b32 v7, v214
  s_nop 1
  v_permlane16_swap_b32 v7, v214
  v_max_f32 v214, v214, v7
  v_mul_f32 v7, s10, v214
  v_fma_f32 v64, v64, s10, -v7
  v_fma_f32 v65, v65, s10, -v7
  v_fma_f32 v66, v66, s10, -v7
  v_fma_f32 v67, v67, s10, -v7
  v_fma_f32 v68, v68, s10, -v7
  v_fma_f32 v69, v69, s10, -v7
  v_fma_f32 v70, v70, s10, -v7
  v_fma_f32 v71, v71, s10, -v7
  v_fma_f32 v72, v72, s10, -v7
  v_fma_f32 v73, v73, s10, -v7
  v_fma_f32 v74, v74, s10, -v7
  v_fma_f32 v75, v75, s10, -v7
  v_fma_f32 v76, v76, s10, -v7
  v_fma_f32 v77, v77, s10, -v7
  v_fma_f32 v78, v78, s10, -v7
  v_fma_f32 v79, v79, s10, -v7
  v_fma_f32 v80, v80, s10, -v7
  v_fma_f32 v81, v81, s10, -v7
  v_fma_f32 v82, v82, s10, -v7
  v_fma_f32 v83, v83, s10, -v7
  v_fma_f32 v84, v84, s10, -v7
  v_fma_f32 v85, v85, s10, -v7
  v_fma_f32 v86, v86, s10, -v7
  v_fma_f32 v87, v87, s10, -v7
  v_exp_f32 v64, v64
  v_exp_f32 v65, v65
  v_exp_f32 v66, v66
  v_exp_f32 v67, v67
  v_exp_f32 v68, v68
  v_exp_f32 v69, v69
  v_exp_f32 v70, v70
  v_exp_f32 v71, v71
  v_exp_f32 v72, v72
  v_exp_f32 v73, v73
  v_exp_f32 v74, v74
  v_exp_f32 v75, v75
  v_exp_f32 v76, v76
  v_exp_f32 v77, v77
  v_exp_f32 v78, v78
  v_exp_f32 v79, v79
  v_exp_f32 v80, v80
  v_exp_f32 v81, v81
  v_exp_f32 v82, v82
  v_exp_f32 v83, v83
  v_exp_f32 v84, v84
  v_exp_f32 v85, v85
  v_exp_f32 v86, v86
  v_exp_f32 v87, v87
  v_add_f32 v215, v64, v65
  v_add_f32 v6, v66, v67
  v_add_f32 v215, v215, v68
  v_add_f32 v6, v6, v69
  v_add_f32 v215, v215, v70
  v_add_f32 v6, v6, v71
  v_add_f32 v215, v215, v72
  v_add_f32 v6, v6, v73
  v_add_f32 v215, v215, v74
  v_add_f32 v6, v6, v75
  v_add_f32 v215, v215, v76
  v_add_f32 v6, v6, v77
  v_add_f32 v215, v215, v78
  v_add_f32 v6, v6, v79
  v_add_f32 v215, v215, v80
  v_add_f32 v6, v6, v81
  v_add_f32 v215, v215, v82
  v_add_f32 v6, v6, v83
  v_add_f32 v215, v215, v84
  v_add_f32 v6, v6, v85
  v_add_f32 v215, v215, v86
  v_add_f32 v6, v6, v87
  v_cvt_pk_bf16_f32 v64, v64, v64
  v_cvt_pk_bf16_f32 v65, v65, v65
  v_cvt_pk_bf16_f32 v66, v66, v66
  v_cvt_pk_bf16_f32 v67, v67, v67
  v_cvt_pk_bf16_f32 v68, v68, v68
  v_cvt_pk_bf16_f32 v69, v69, v69
  v_cvt_pk_bf16_f32 v70, v70, v70
  v_cvt_pk_bf16_f32 v71, v71, v71
  v_cvt_pk_bf16_f32 v72, v72, v72
  v_cvt_pk_bf16_f32 v73, v73, v73
  v_cvt_pk_bf16_f32 v74, v74, v74
  v_cvt_pk_bf16_f32 v75, v75, v75
  v_cvt_pk_bf16_f32 v76, v76, v76
  v_cvt_pk_bf16_f32 v77, v77, v77
  v_cvt_pk_bf16_f32 v78, v78, v78
  v_cvt_pk_bf16_f32 v79, v79, v79
  v_cvt_pk_bf16_f32 v80, v80, v80
  v_cvt_pk_bf16_f32 v81, v81, v81
  v_cvt_pk_bf16_f32 v82, v82, v82
  v_cvt_pk_bf16_f32 v83, v83, v83
  v_cvt_pk_bf16_f32 v84, v84, v84
  v_cvt_pk_bf16_f32 v85, v85, v85
  v_cvt_pk_bf16_f32 v86, v86, v86
  v_cvt_pk_bf16_f32 v87, v87, v87
  s_mov_b32 exec_lo, 0x01010101
  s_mov_b32 exec_hi, 0x01010101
  ds_write_b128 v213, v[64:67] offset:0
  ds_write_b128 v213, v[68:71] offset:128
  ds_write_b128 v213, v[72:75] offset:256
  ds_write_b128 v213, v[76:79] offset:384
  s_cmp_le_u32 s97, 4
  s_cbranch_scc1 Lpe_30
  ds_write_b128 v213, v[80:83] offset:512
  s_cmp_le_u32 s97, 5
  s_cbranch_scc1 Lpe_30
  ds_write_b128 v213, v[84:87] offset:640
Lpe_30:
  s_mov_b64 exec, -1
  s_lshl_b32 s9, s5, 2
  s_add_u32 s9, s9, 7024
  v_mov_b32 v9, s9
  v_mov_b32 v10, 1
  s_waitcnt lgkmcnt(0)
  s_mov_b64 exec, 1
  ds_write_b32 v9, v10
  s_mov_b64 exec, -1
  v_add_f32 v215, v215, v6
  v_mov_b32 v7, v215
  s_nop 1
  v_permlane32_swap_b32 v7, v215
  v_add_f32 v215, v215, v7
  v_mov_b32 v7, v215
  s_nop 1
  v_permlane16_swap_b32 v7, v215
  v_add_f32 v215, v215, v7
  v_bfe_u32 v8, v1, 3, 1
  v_lshlrev_b32 v8, 3, v8
  s_lshl_b32 s9, s5, 4
  s_add_u32 s9, s9, 6912
  v_add_u32 v9, s9, v8
  s_mov_b32 exec_lo, 0x101
  s_mov_b32 exec_hi, 0
  ds_write_b64 v9, v[214:215]
  s_mov_b64 exec, -1
  s_waitcnt lgkmcnt(0)
  v_mov_b32 v6, 7012
  v_mov_b32 v7, 1
  s_mov_b64 exec, 1
  ds_add_u32 v6, v7
  s_mov_b64 exec, -1
  s_cmp_lg_u32 s5, 0
  s_cbranch_scc1 Lml_31
  v_mov_b32 v10, 7012
  s_mov_b32 s15, 0
Lsp_32:
  ds_read_b32 v7, v10
  s_add_u32 s15, s15, 1
  s_waitcnt lgkmcnt(0)
  v_readfirstlane_b32 s8, v7
  s_nop 0
  s_cmp_ge_u32 s8, 4
  s_cbranch_scc1 Lspo_33
  s_cmp_lt_u32 s15, 160000
  s_cbranch_scc1 Lsp_32
Lspo_33:
  v_and_b32 v6, 7, v1
  v_lshlrev_b32 v9, 3, v6
  ds_read_b64 v[48:49], v9 offset:6912
  s_mul_i32 s8, s3, 256
  s_lshl_b32 s9, s4, 4
  s_add_u32 s8, s8, s9
  s_add_u32 s8, s8, 0x50000
  v_mov_b32 v12, s8
  s_mov_b32 s10, 0x3fb8aa3b
  s_waitcnt lgkmcnt(0)
  v_mov_b32 v50, v48
  s_nop 1
  v_max_f32_dpp v50, v50, v50 quad_perm:[2,3,0,1] row_mask:0xf bank_mask:0xf
  s_nop 1
  v_max_f32_dpp v50, v50, v50 row_ror:4 row_mask:0xf bank_mask:0xf
  v_sub_f32 v48, v48, v50
  v_mul_f32 v48, s10, v48
  v_exp_f32 v48, v48
  s_nop 0
  v_mul_f32 v51, v48, v49
  s_nop 1
  v_add_f32_dpp v51, v51, v51 quad_perm:[2,3,0,1] row_mask:0xf bank_mask:0xf
  s_nop 1
  v_add_f32_dpp v51, v51, v51 row_ror:4 row_mask:0xf bank_mask:0xf
  v_lshlrev_b32 v9, 2, v6
  s_mov_b32 exec_lo, 0xff
  s_mov_b32 exec_hi, 0
  ds_write_b32 v9, v48 offset:6976
  s_mov_b64 exec, -1
  v_mov_b32 v52, v50
  v_mov_b32 v53, v51
  v_mov_b32_dpp v54, v50 quad_perm:[1,0,3,2] row_mask:0xf bank_mask:0xf
  v_mov_b32_dpp v55, v51 quad_perm:[1,0,3,2] row_mask:0xf bank_mask:0xf
  v_bfi_b32 v52, s14, v14, v52
  v_bfi_b32 v53, s14, v14, v53
  v_bfi_b32 v54, s14, v14, v54
  v_bfi_b32 v55, s14, v14, v55
  s_waitcnt lgkmcnt(0)
  v_mov_b32 v6, 7020
  v_mov_b32 v7, 1
  s_mov_b64 exec, 1
  ds_add_u32 v6, v7
  s_mov_b64 exec, -1
  s_mov_b64 exec, 1
  buffer_store_dwordx4 v[52:55], v12, s[44:47], 0 offen offset:0 sc1
  s_mov_b64 exec, -1
Lml_31:
  v_mov_b32 v10, 7040
  ds_read_b32 v10, v10
  s_waitcnt lgkmcnt(0)
  v_readfirstlane_b32 s96, v10
  s_nop 0
  s_mul_i32 s8, s96, 2731
  s_lshr_b32 s8, s8, 16
  s_mul_i32 s9, s8, 24
  s_sub_u32 s9, s96, s9
  s_mul_i32 s9, s9, 24
  s_mul_i32 s10, s5, 6
  s_add_u32 s9, s9, s10
  s_mul_i32 s9, s9, 9216
  s_mul_i32 s8, s8, 1152
  s_add_u32 s9, s9, s8
  v_add_u32 v218, s9, v242
  v_lshrrev_b32 v6, 3, v1
  v_mul_u32_u24 v6, 9216, v6
  v_and_b32 v7, 7, v1
  v_lshlrev_b32 v7, 4, v7
  s_add_u32 s9, s9, 1024
  v_add3_u32 v219, v6, v7, s9
  s_mov_b32 s48, s28
  s_mov_b32 s49, s29
  s_mov_b32 s50, 0x510000
  s_mov_b32 s51, 0x00020000
  s_mov_b32 s52, s30
  s_mov_b32 s53, s31
  s_mov_b32 s54, 0x510000
  s_mov_b32 s55, 0x00020000
  s_mov_b32 s9, 0
  buffer_load_dwordx4 v[128:131], v218, s[48:51], s9 offen
  s_mov_b32 s9, 0
  buffer_load_dwordx4 v[132:135], v218, s[52:55], s9 offen
  v_mov_b32 v10, 7048
  s_mov_b32 s15, 0
Lsp_34:
  ds_read_b32 v7, v10
  s_add_u32 s15, s15, 1
  s_waitcnt lgkmcnt(0)
  v_readfirstlane_b32 s8, v7
  s_nop 0
  s_cmp_ge_u32 s8, 1
  s_cbranch_scc1 Lspo_35
  s_cmp_lt_u32 s15, 160000
  s_cbranch_scc1 Lsp_34
Lspo_35:
  s_mov_b32 s9, 9216
  buffer_load_dwordx4 v[136:139], v218, s[48:51], s9 offen
  s_mov_b32 s9, 9216
  buffer_load_dwordx4 v[140:143], v218, s[52:55], s9 offen
  s_mov_b32 s9, 18432
  buffer_load_dwordx4 v[144:147], v218, s[48:51], s9 offen
  s_mov_b32 s9, 18432
  buffer_load_dwordx4 v[148:151], v218, s[52:55], s9 offen
  s_mov_b32 s9, 27648
  buffer_load_dwordx4 v[152:155], v218, s[48:51], s9 offen
  s_mov_b32 s9, 27648
  buffer_load_dwordx4 v[156:159], v218, s[52:55], s9 offen
  s_mov_b32 s9, 36864
  buffer_load_dwordx4 v[128:131], v218, s[48:51], s9 offen
  s_mov_b32 s9, 36864
  buffer_load_dwordx4 v[132:135], v218, s[52:55], s9 offen
  s_mov_b32 s9, 46080
  buffer_load_dwordx4 v[136:139], v218, s[48:51], s9 offen
  s_mov_b32 s9, 46080
  buffer_load_dwordx4 v[140:143], v218, s[52:55], s9 offen
  s_mov_b32 exec_lo, 0xffffffff
  s_mov_b32 exec_hi, 0xffff
  buffer_load_dwordx4 v[144:147], v219, s[48:51], 0 offen
  s_mov_b64 exec, -1
  s_mov_b32 exec_lo, 0xffffffff
  s_mov_b32 exec_hi, 0xffff
  buffer_load_dwordx4 v[148:151], v219, s[52:55], 0 offen
  s_mov_b64 exec, -1
  s_mov_b32 s56, s32
  s_mov_b32 s57, s33
  s_mov_b32 s58, 0x510000
  s_mov_b32 s59, 0x00020000
  s_mov_b32 s60, 9216
  s_mov_b32 s61, 18432
  v_lshrrev_b32 v6, 3, v1
  s_mul_i32 s8, s96, 24
  v_add_u32 v6, s8, v6
  v_mul_u32_u24 v6, 1152, v6
  v_and_b32 v7, 7, v1
  v_lshlrev_b32 v7, 4, v7
  s_lshl_b32 s8, s5, 7
  v_add3_u32 v6, v6, v7, s8
  buffer_load_dwordx4 v[164:167], v6, s[56:59], 0 offen nt
  buffer_load_dwordx4 v[168:171], v6, s[56:59], s60 offen nt
  buffer_load_dwordx4 v[172:175], v6, s[56:59], s61 offen nt
  s_waitcnt vmcnt(3)
  s_branch L_Fjoin
L_FV:
  s_mov_b32 s52, s20
  s_mov_b32 s53, s21
  s_mov_b32 s54, 0x10000000
  s_mov_b32 s55, 0x00020000
  s_cmp_eq_u32 s97, 5
  s_cbranch_scc1 L_FV5
  s_cmp_eq_u32 s97, 6
  s_cbranch_scc1 L_FV6
  v_mov_b32 v10, 7044
  s_mov_b32 s15, 0
Lsp_36:
  ds_read_b32 v7, v10
  s_add_u32 s15, s15, 1
  s_waitcnt lgkmcnt(0)
  v_readfirstlane_b32 s8, v7
  s_nop 0
  s_cmp_ge_u32 s8, 4
  s_cbranch_scc1 Lspo_37
  s_cmp_lt_u32 s15, 160000
  s_cbranch_scc1 Lsp_36
Lspo_37:
  s_mov_b32 s8, 0
  s_nop 0
  buffer_load_dwordx4 v[16:19], v209, s[52:55], s8 offen offset:0 nt
  buffer_load_dwordx4 v[20:23], v209, s[52:55], s8 offen offset:1024 nt
  buffer_load_dwordx4 v[24:27], v209, s[52:55], s8 offen offset:2048 nt
  buffer_load_dwordx4 v[28:31], v209, s[52:55], s8 offen offset:3072 nt
  s_mov_b32 s8, 4096
  buffer_load_dwordx4 v[32:35], v209, s[52:55], s8 offen offset:0 nt
  buffer_load_dwordx4 v[36:39], v209, s[52:55], s8 offen offset:1024 nt
  buffer_load_dwordx4 v[40:43], v209, s[52:55], s8 offen offset:2048 nt
  buffer_load_dwordx4 v[44:47], v209, s[52:55], s8 offen offset:3072 nt
  s_mov_b32 s8, 8192
  buffer_load_dwordx4 v[48:51], v209, s[52:55], s8 offen offset:0 nt
  buffer_load_dwordx4 v[52:55], v209, s[52:55], s8 offen offset:1024 nt
  buffer_load_dwordx4 v[56:59], v209, s[52:55], s8 offen offset:2048 nt
  buffer_load_dwordx4 v[60:63], v209, s[52:55], s8 offen offset:3072 nt
  s_mov_b32 s8, 12288
  buffer_load_dwordx4 v[64:67], v209, s[52:55], s8 offen offset:0 nt
  buffer_load_dwordx4 v[68:71], v209, s[52:55], s8 offen offset:1024 nt
  buffer_load_dwordx4 v[72:75], v209, s[52:55], s8 offen offset:2048 nt
  buffer_load_dwordx4 v[76:79], v209, s[52:55], s8 offen offset:3072 nt
  s_waitcnt lgkmcnt(0)
  s_add_u32 s6, s7, 1
  s_and_b32 s6, s6, 0xff
  v_mov_b32 v14, s6
  s_and_b32 s9, s5, 3
  s_lshl_b32 s9, s9, 2
  s_add_u32 s9, s9, 7024
  v_mov_b32 v10, s9
  v_lshrrev_b32 v8, 4, v1
  v_lshlrev_b32 v8, 5, v8
  v_bfe_u32 v9, v1, 3, 1
  v_lshlrev_b32 v9, 4, v9
  v_add3_u32 v8, v8, v9, s27
  s_and_b32 s9, s5, 3
  s_lshl_b32 s9, s9, 10
  v_add_u32 v12, s9, v242
  s_mov_b32 s15, 0
Lsp_38:
  ds_read_b32 v7, v10
  s_add_u32 s15, s15, 1
  s_waitcnt lgkmcnt(0)
  v_readfirstlane_b32 s8, v7
  s_nop 0
  s_cmp_ge_u32 s8, 1
  s_cbranch_scc1 Lspo_39
  s_cmp_lt_u32 s15, 160000
  s_cbranch_scc1 Lsp_38
Lspo_39:
  ds_read_b128 v[112:115], v8 offset:0
  ds_read_b128 v[116:119], v8 offset:128
  ds_read_b128 v[120:123], v8 offset:256
  ds_read_b128 v[124:127], v8 offset:384
  s_waitcnt lgkmcnt(0)
  v_and_b32 v136, v112, v2
  v_and_b32 v137, v112, v3
  v_and_b32 v138, v112, v4
  v_and_b32 v139, v112, v5
  v_and_b32 v140, v113, v2
  v_and_b32 v141, v113, v3
  v_and_b32 v142, v113, v4
  v_and_b32 v143, v113, v5
  s_waitcnt vmcnt(12)
  v_mfma_f32_16x16x32_bf16 v[144:147], v[16:19], v[136:139], 0
  v_and_b32 v136, v114, v2
  v_and_b32 v137, v114, v3
  v_and_b32 v138, v114, v4
  v_and_b32 v139, v114, v5
  v_mfma_f32_16x16x32_bf16 v[144:147], v[20:23], v[140:143], v[144:147]
  v_and_b32 v140, v115, v2
  v_and_b32 v141, v115, v3
  v_and_b32 v142, v115, v4
  v_and_b32 v143, v115, v5
  v_mfma_f32_16x16x32_bf16 v[144:147], v[24:27], v[136:139], v[144:147]
  v_and_b32 v136, v116, v2
  v_and_b32 v137, v116, v3
  v_and_b32 v138, v116, v4
  v_and_b32 v139, v116, v5
  v_mfma_f32_16x16x32_bf16 v[144:147], v[28:31], v[140:143], v[144:147]
  v_and_b32 v140, v117, v2
  v_and_b32 v141, v117, v3
  v_and_b32 v142, v117, v4
  v_and_b32 v143, v117, v5
  s_waitcnt vmcnt(8)
  v_mfma_f32_16x16x32_bf16 v[144:147], v[32:35], v[136:139], v[144:147]
  v_and_b32 v136, v118, v2
  v_and_b32 v137, v118, v3
  v_and_b32 v138, v118, v4
  v_and_b32 v139, v118, v5
  v_mfma_f32_16x16x32_bf16 v[144:147], v[36:39], v[140:143], v[144:147]
  v_and_b32 v140, v119, v2
  v_and_b32 v141, v119, v3
  v_and_b32 v142, v119, v4
  v_and_b32 v143, v119, v5
  v_mfma_f32_16x16x32_bf16 v[144:147], v[40:43], v[136:139], v[144:147]
  v_and_b32 v136, v120, v2
  v_and_b32 v137, v120, v3
  v_and_b32 v138, v120, v4
  v_and_b32 v139, v120, v5
  v_mfma_f32_16x16x32_bf16 v[144:147], v[44:47], v[140:143], v[144:147]
  v_and_b32 v140, v121, v2
  v_and_b32 v141, v121, v3
  v_and_b32 v142, v121, v4
  v_and_b32 v143, v121, v5
  s_waitcnt vmcnt(4)
  v_mfma_f32_16x16x32_bf16 v[144:147], v[48:51], v[136:139], v[144:147]
  v_and_b32 v136, v122, v2
  v_and_b32 v137, v122, v3
  v_and_b32 v138, v122, v4
  v_and_b32 v139, v122, v5
  v_mfma_f32_16x16x32_bf16 v[144:147], v[52:55], v[140:143], v[144:147]
  v_and_b32 v140, v123, v2
  v_and_b32 v141, v123, v3
  v_and_b32 v142, v123, v4
  v_and_b32 v143, v123, v5
  v_mfma_f32_16x16x32_bf16 v[144:147], v[56:59], v[136:139], v[144:147]
  v_and_b32 v136, v124, v2
  v_and_b32 v137, v124, v3
  v_and_b32 v138, v124, v4
  v_and_b32 v139, v124, v5
  v_mfma_f32_16x16x32_bf16 v[144:147], v[60:63], v[140:143], v[144:147]
  v_and_b32 v140, v125, v2
  v_and_b32 v141, v125, v3
  v_and_b32 v142, v125, v4
  v_and_b32 v143, v125, v5
  s_waitcnt vmcnt(0)
  v_mfma_f32_16x16x32_bf16 v[144:147], v[64:67], v[136:139], v[144:147]
  v_and_b32 v136, v126, v2
  v_and_b32 v137, v126, v3
  v_and_b32 v138, v126, v4
  v_and_b32 v139, v126, v5
  v_mfma_f32_16x16x32_bf16 v[144:147], v[68:71], v[140:143], v[144:147]
  v_and_b32 v140, v127, v2
  v_and_b32 v141, v127, v3
  v_and_b32 v142, v127, v4
  v_and_b32 v143, v127, v5
  v_mfma_f32_16x16x32_bf16 v[144:147], v[72:75], v[136:139], v[144:147]
  s_nop 0
  v_mfma_f32_16x16x32_bf16 v[144:147], v[76:79], v[140:143], v[144:147]
  s_nop 7
  ds_write_b128 v12, v[144:147] offset:13312
  s_waitcnt lgkmcnt(0)
  v_mov_b32 v6, 7016
  v_mov_b32 v7, 1
  s_mov_b64 exec, 1
  ds_add_u32 v6, v7
  s_mov_b64 exec, -1
  s_cmp_lg_u32 s5, 7
  s_cbranch_scc1 Lpub_40
  s_mul_i32 s8, s3, 12
  s_add_u32 s8, s8, s4
  s_lshl_b32 s9, s8, 10
  s_add_u32 s9, s9, 0x20000
  v_add_u32 v9, s9, v242
  v_mov_b32 v10, 7020
  v_bfe_u32 v8, v1, 3, 1
  v_lshlrev_b32 v8, 2, v8
  s_mov_b32 s15, 0
Lsp_41:
  ds_read_b32 v7, v10
  s_add_u32 s15, s15, 1
  s_waitcnt lgkmcnt(0)
  v_readfirstlane_b32 s8, v7
  s_nop 0
  s_cmp_ge_u32 s8, 1
  s_cbranch_scc1 Lspo_42
  s_cmp_lt_u32 s15, 160000
  s_cbranch_scc1 Lsp_41
Lspo_42:
  ds_read_b32 v32, v8 offset:6976
  ds_read_b32 v33, v8 offset:6984
  ds_read_b32 v34, v8 offset:6992
  ds_read_b32 v35, v8 offset:7000
  v_mov_b32 v10, 7016
  s_mov_b32 s15, 0
Lsp_43:
  ds_read_b32 v7, v10
  s_add_u32 s15, s15, 1
  s_waitcnt lgkmcnt(0)
  v_readfirstlane_b32 s8, v7
  s_nop 0
  s_cmp_ge_u32 s8, 4
  s_cbranch_scc1 Lspo_44
  s_cmp_lt_u32 s15, 160000
  s_cbranch_scc1 Lsp_43
Lspo_44:
  ds_read_b128 v[16:19], v242 offset:13312
  ds_read_b128 v[20:23], v242 offset:14336
  ds_read_b128 v[24:27], v242 offset:15360
  ds_read_b128 v[28:31], v242 offset:16384
  s_waitcnt lgkmcnt(0)
  v_mul_f32 v16, v16, v32
  v_mul_f32 v17, v17, v32
  v_mul_f32 v18, v18, v32
  v_mul_f32 v19, v19, v32
  v_fmac_f32 v16, v20, v33
  v_fmac_f32 v17, v21, v33
  v_fmac_f32 v18, v22, v33
  v_fmac_f32 v19, v23, v33
  v_fmac_f32 v16, v24, v34
  v_fmac_f32 v17, v25, v34
  v_fmac_f32 v18, v26, v34
  v_fmac_f32 v19, v27, v34
  v_fmac_f32 v16, v28, v35
  v_fmac_f32 v17, v29, v35
  v_fmac_f32 v18, v30, v35
  v_fmac_f32 v19, v31, v35
  v_bfi_b32 v16, s14, v14, v16
  v_bfi_b32 v17, s14, v14, v17
  v_bfi_b32 v18, s14, v14, v18
  v_bfi_b32 v19, s14, v14, v19
  buffer_store_dwordx4 v[16:19], v9, s[44:47], 0 offen offset:0 sc1
  v_mov_b32 v6, 7048
  v_mov_b32 v7, 1
  s_mov_b64 exec, 1
  ds_add_u32 v6, v7
  s_mov_b64 exec, -1
Lpub_40:
  v_mov_b32 v10, 7040
  ds_read_b32 v10, v10
  s_waitcnt lgkmcnt(0)
  v_readfirstlane_b32 s96, v10
  s_mov_b32 s56, s32
  s_mov_b32 s57, s33
  s_mov_b32 s58, 0x510000
  s_mov_b32 s59, 0x00020000
  s_mov_b32 s60, 9216
  s_mov_b32 s61, 18432
  v_lshrrev_b32 v6, 3, v1
  s_mul_i32 s8, s96, 24
  v_add_u32 v6, s8, v6
  v_mul_u32_u24 v6, 1152, v6
  v_and_b32 v7, 7, v1
  v_lshlrev_b32 v7, 4, v7
  s_lshl_b32 s8, s5, 7
  v_add3_u32 v6, v6, v7, s8
  buffer_load_dwordx4 v[164:167], v6, s[56:59], 0 offen nt
  buffer_load_dwordx4 v[168:171], v6, s[56:59], s60 offen nt
  buffer_load_dwordx4 v[172:175], v6, s[56:59], s61 offen nt
  s_cmp_lg_u32 s5, 4
  s_cbranch_scc1 Ld8_45
  buffer_load_dwordx4 v[176:179], v6, s[56:59], 0 offen offset:512 nt
  buffer_load_dwordx4 v[180:183], v6, s[56:59], s60 offen offset:512 nt
  buffer_load_dwordx4 v[184:187], v6, s[56:59], s61 offen offset:512 nt
Ld8_45:
  s_branch L_Fjoin
L_FV5:
  v_mov_b32 v10, 7044
  s_mov_b32 s15, 0
Lsp_46:
  ds_read_b32 v7, v10
  s_add_u32 s15, s15, 1
  s_waitcnt lgkmcnt(0)
  v_readfirstlane_b32 s8, v7
  s_nop 0
  s_cmp_ge_u32 s8, 4
  s_cbranch_scc1 Lspo_47
  s_cmp_lt_u32 s15, 160000
  s_cbranch_scc1 Lsp_46
Lspo_47:
  s_mov_b32 s8, 0
  s_nop 0
  buffer_load_dwordx4 v[16:19], v209, s[52:55], s8 offen offset:0 nt
  buffer_load_dwordx4 v[20:23], v209, s[52:55], s8 offen offset:1024 nt
  buffer_load_dwordx4 v[24:27], v209, s[52:55], s8 offen offset:2048 nt
  buffer_load_dwordx4 v[28:31], v209, s[52:55], s8 offen offset:3072 nt
  s_mov_b32 s8, 4096
  buffer_load_dwordx4 v[32:35], v209, s[52:55], s8 offen offset:0 nt
  buffer_load_dwordx4 v[36:39], v209, s[52:55], s8 offen offset:1024 nt
  buffer_load_dwordx4 v[40:43], v209, s[52:55], s8 offen offset:2048 nt
  buffer_load_dwordx4 v[44:47], v209, s[52:55], s8 offen offset:3072 nt
  s_mov_b32 s8, 8192
  buffer_load_dwordx4 v[48:51], v209, s[52:55], s8 offen offset:0 nt
  buffer_load_dwordx4 v[52:55], v209, s[52:55], s8 offen offset:1024 nt
  buffer_load_dwordx4 v[56:59], v209, s[52:55], s8 offen offset:2048 nt
  buffer_load_dwordx4 v[60:63], v209, s[52:55], s8 offen offset:3072 nt
  s_mov_b32 s8, 12288
  buffer_load_dwordx4 v[64:67], v209, s[52:55], s8 offen offset:0 nt
  buffer_load_dwordx4 v[68:71], v209, s[52:55], s8 offen offset:1024 nt
  buffer_load_dwordx4 v[72:75], v209, s[52:55], s8 offen offset:2048 nt
  buffer_load_dwordx4 v[76:79], v209, s[52:55], s8 offen offset:3072 nt
  s_mov_b32 s8, 16384
  buffer_load_dwordx4 v[80:83], v209, s[52:55], s8 offen offset:0 nt
  buffer_load_dwordx4 v[84:87], v209, s[52:55], s8 offen offset:1024 nt
  buffer_load_dwordx4 v[88:91], v209, s[52:55], s8 offen offset:2048 nt
  buffer_load_dwordx4 v[92:95], v209, s[52:55], s8 offen offset:3072 nt
  s_waitcnt lgkmcnt(0)
  s_add_u32 s6, s7, 1
  s_and_b32 s6, s6, 0xff
  v_mov_b32 v14, s6
  s_and_b32 s9, s5, 3
  s_lshl_b32 s9, s9, 2
  s_add_u32 s9, s9, 7024
  v_mov_b32 v10, s9
  v_lshrrev_b32 v8, 4, v1
  v_lshlrev_b32 v8, 5, v8
  v_bfe_u32 v9, v1, 3, 1
  v_lshlrev_b32 v9, 4, v9
  v_add3_u32 v8, v8, v9, s27
  s_and_b32 s9, s5, 3
  s_lshl_b32 s9, s9, 10
  v_add_u32 v12, s9, v242
  s_mov_b32 s15, 0
Lsp_48:
  ds_read_b32 v7, v10
  s_add_u32 s15, s15, 1
  s_waitcnt lgkmcnt(0)
  v_readfirstlane_b32 s8, v7
  s_nop 0
  s_cmp_ge_u32 s8, 1
  s_cbranch_scc1 Lspo_49
  s_cmp_lt_u32 s15, 160000
  s_cbranch_scc1 Lsp_48
Lspo_49:
  ds_read_b128 v[112:115], v8 offset:0
  ds_read_b128 v[116:119], v8 offset:128
  ds_read_b128 v[120:123], v8 offset:256
  ds_read_b128 v[124:127], v8 offset:384
  ds_read_b128 v[128:131], v8 offset:512
  s_waitcnt lgkmcnt(0)
  v_and_b32 v136, v112, v2
  v_and_b32 v137, v112, v3
  v_and_b32 v138, v112, v4
  v_and_b32 v139, v112, v5
  v_and_b32 v140, v113, v2
  v_and_b32 v141, v113, v3
  v_and_b32 v142, v113, v4
  v_and_b32 v143, v113, v5
  s_waitcnt vmcnt(16)
  v_mfma_f32_16x16x32_bf16 v[144:147], v[16:19], v[136:139], 0
  v_and_b32 v136, v114, v2
  v_and_b32 v137, v114, v3
  v_and_b32 v138, v114, v4
  v_and_b32 v139, v114, v5
  v_mfma_f32_16x16x32_bf16 v[144:147], v[20:23], v[140:143], v[144:147]
  v_and_b32 v140, v115, v2
  v_and_b32 v141, v115, v3
  v_and_b32 v142, v115, v4
  v_and_b32 v143, v115, v5
  v_mfma_f32_16x16x32_bf16 v[144:147], v[24:27], v[136:139], v[144:147]
  v_and_b32 v136, v116, v2
  v_and_b32 v137, v116, v3
  v_and_b32 v138, v116, v4
  v_and_b32 v139, v116, v5
  v_mfma_f32_16x16x32_bf16 v[144:147], v[28:31], v[140:143], v[144:147]
  v_and_b32 v140, v117, v2
  v_and_b32 v141, v117, v3
  v_and_b32 v142, v117, v4
  v_and_b32 v143, v117, v5
  s_waitcnt vmcnt(12)
  v_mfma_f32_16x16x32_bf16 v[144:147], v[32:35], v[136:139], v[144:147]
  v_and_b32 v136, v118, v2
  v_and_b32 v137, v118, v3
  v_and_b32 v138, v118, v4
  v_and_b32 v139, v118, v5
  v_mfma_f32_16x16x32_bf16 v[144:147], v[36:39], v[140:143], v[144:147]
  v_and_b32 v140, v119, v2
  v_and_b32 v141, v119, v3
  v_and_b32 v142, v119, v4
  v_and_b32 v143, v119, v5
  v_mfma_f32_16x16x32_bf16 v[144:147], v[40:43], v[136:139], v[144:147]
  v_and_b32 v136, v120, v2
  v_and_b32 v137, v120, v3
  v_and_b32 v138, v120, v4
  v_and_b32 v139, v120, v5
  v_mfma_f32_16x16x32_bf16 v[144:147], v[44:47], v[140:143], v[144:147]
  v_and_b32 v140, v121, v2
  v_and_b32 v141, v121, v3
  v_and_b32 v142, v121, v4
  v_and_b32 v143, v121, v5
  s_waitcnt vmcnt(8)
  v_mfma_f32_16x16x32_bf16 v[144:147], v[48:51], v[136:139], v[144:147]
  v_and_b32 v136, v122, v2
  v_and_b32 v137, v122, v3
  v_and_b32 v138, v122, v4
  v_and_b32 v139, v122, v5
  v_mfma_f32_16x16x32_bf16 v[144:147], v[52:55], v[140:143], v[144:147]
  v_and_b32 v140, v123, v2
  v_and_b32 v141, v123, v3
  v_and_b32 v142, v123, v4
  v_and_b32 v143, v123, v5
  v_mfma_f32_16x16x32_bf16 v[144:147], v[56:59], v[136:139], v[144:147]
  v_and_b32 v136, v124, v2
  v_and_b32 v137, v124, v3
  v_and_b32 v138, v124, v4
  v_and_b32 v139, v124, v5
  v_mfma_f32_16x16x32_bf16 v[144:147], v[60:63], v[140:143], v[144:147]
  v_and_b32 v140, v125, v2
  v_and_b32 v141, v125, v3
  v_and_b32 v142, v125, v4
  v_and_b32 v143, v125, v5
  s_waitcnt vmcnt(4)
  v_mfma_f32_16x16x32_bf16 v[144:147], v[64:67], v[136:139], v[144:147]
  v_and_b32 v136, v126, v2
  v_and_b32 v137, v126, v3
  v_and_b32 v138, v126, v4
  v_and_b32 v139, v126, v5
  v_mfma_f32_16x16x32_bf16 v[144:147], v[68:71], v[140:143], v[144:147]
  v_and_b32 v140, v127, v2
  v_and_b32 v141, v127, v3
  v_and_b32 v142, v127, v4
  v_and_b32 v143, v127, v5
  v_mfma_f32_16x16x32_bf16 v[144:147], v[72:75], v[136:139], v[144:147]
  v_and_b32 v136, v128, v2
  v_and_b32 v137, v128, v3
  v_and_b32 v138, v128, v4
  v_and_b32 v139, v128, v5
  v_mfma_f32_16x16x32_bf16 v[144:147], v[76:79], v[140:143], v[144:147]
  v_and_b32 v140, v129, v2
  v_and_b32 v141, v129, v3
  v_and_b32 v142, v129, v4
  v_and_b32 v143, v129, v5
  s_waitcnt vmcnt(0)
  v_mfma_f32_16x16x32_bf16 v[144:147], v[80:83], v[136:139], v[144:147]
  v_and_b32 v136, v130, v2
  v_and_b32 v137, v130, v3
  v_and_b32 v138, v130, v4
  v_and_b32 v139, v130, v5
  v_mfma_f32_16x16x32_bf16 v[144:147], v[84:87], v[140:143], v[144:147]
  v_and_b32 v140, v131, v2
  v_and_b32 v141, v131, v3
  v_and_b32 v142, v131, v4
  v_and_b32 v143, v131, v5
  v_mfma_f32_16x16x32_bf16 v[144:147], v[88:91], v[136:139], v[144:147]
  s_nop 0
  v_mfma_f32_16x16x32_bf16 v[144:147], v[92:95], v[140:143], v[144:147]
  s_nop 7
  ds_write_b128 v12, v[144:147] offset:13312
  s_waitcnt lgkmcnt(0)
  v_mov_b32 v6, 7016
  v_mov_b32 v7, 1
  s_mov_b64 exec, 1
  ds_add_u32 v6, v7
  s_mov_b64 exec, -1
  s_cmp_lg_u32 s5, 7
  s_cbranch_scc1 Lpub_50
  s_mul_i32 s8, s3, 12
  s_add_u32 s8, s8, s4
  s_lshl_b32 s9, s8, 10
  s_add_u32 s9, s9, 0x20000
  v_add_u32 v9, s9, v242
  v_mov_b32 v10, 7020
  v_bfe_u32 v8, v1, 3, 1
  v_lshlrev_b32 v8, 2, v8
  s_mov_b32 s15, 0
Lsp_51:
  ds_read_b32 v7, v10
  s_add_u32 s15, s15, 1
  s_waitcnt lgkmcnt(0)
  v_readfirstlane_b32 s8, v7
  s_nop 0
  s_cmp_ge_u32 s8, 1
  s_cbranch_scc1 Lspo_52
  s_cmp_lt_u32 s15, 160000
  s_cbranch_scc1 Lsp_51
Lspo_52:
  ds_read_b32 v32, v8 offset:6976
  ds_read_b32 v33, v8 offset:6984
  ds_read_b32 v34, v8 offset:6992
  ds_read_b32 v35, v8 offset:7000
  v_mov_b32 v10, 7016
  s_mov_b32 s15, 0
Lsp_53:
  ds_read_b32 v7, v10
  s_add_u32 s15, s15, 1
  s_waitcnt lgkmcnt(0)
  v_readfirstlane_b32 s8, v7
  s_nop 0
  s_cmp_ge_u32 s8, 4
  s_cbranch_scc1 Lspo_54
  s_cmp_lt_u32 s15, 160000
  s_cbranch_scc1 Lsp_53
Lspo_54:
  ds_read_b128 v[16:19], v242 offset:13312
  ds_read_b128 v[20:23], v242 offset:14336
  ds_read_b128 v[24:27], v242 offset:15360
  ds_read_b128 v[28:31], v242 offset:16384
  s_waitcnt lgkmcnt(0)
  v_mul_f32 v16, v16, v32
  v_mul_f32 v17, v17, v32
  v_mul_f32 v18, v18, v32
  v_mul_f32 v19, v19, v32
  v_fmac_f32 v16, v20, v33
  v_fmac_f32 v17, v21, v33
  v_fmac_f32 v18, v22, v33
  v_fmac_f32 v19, v23, v33
  v_fmac_f32 v16, v24, v34
  v_fmac_f32 v17, v25, v34
  v_fmac_f32 v18, v26, v34
  v_fmac_f32 v19, v27, v34
  v_fmac_f32 v16, v28, v35
  v_fmac_f32 v17, v29, v35
  v_fmac_f32 v18, v30, v35
  v_fmac_f32 v19, v31, v35
  v_bfi_b32 v16, s14, v14, v16
  v_bfi_b32 v17, s14, v14, v17
  v_bfi_b32 v18, s14, v14, v18
  v_bfi_b32 v19, s14, v14, v19
  buffer_store_dwordx4 v[16:19], v9, s[44:47], 0 offen offset:0 sc1
  v_mov_b32 v6, 7048
  v_mov_b32 v7, 1
  s_mov_b64 exec, 1
  ds_add_u32 v6, v7
  s_mov_b64 exec, -1
Lpub_50:
  v_mov_b32 v10, 7040
  ds_read_b32 v10, v10
  s_waitcnt lgkmcnt(0)
  v_readfirstlane_b32 s96, v10
  s_mov_b32 s56, s32
  s_mov_b32 s57, s33
  s_mov_b32 s58, 0x510000
  s_mov_b32 s59, 0x00020000
  s_mov_b32 s60, 9216
  s_mov_b32 s61, 18432
  v_lshrrev_b32 v6, 3, v1
  s_mul_i32 s8, s96, 24
  v_add_u32 v6, s8, v6
  v_mul_u32_u24 v6, 1152, v6
  v_and_b32 v7, 7, v1
  v_lshlrev_b32 v7, 4, v7
  s_lshl_b32 s8, s5, 7
  v_add3_u32 v6, v6, v7, s8
  buffer_load_dwordx4 v[164:167], v6, s[56:59], 0 offen nt
  buffer_load_dwordx4 v[168:171], v6, s[56:59], s60 offen nt
  buffer_load_dwordx4 v[172:175], v6, s[56:59], s61 offen nt
  s_cmp_lg_u32 s5, 4
  s_cbranch_scc1 Ld8_55
  buffer_load_dwordx4 v[176:179], v6, s[56:59], 0 offen offset:512 nt
  buffer_load_dwordx4 v[180:183], v6, s[56:59], s60 offen offset:512 nt
  buffer_load_dwordx4 v[184:187], v6, s[56:59], s61 offen offset:512 nt
Ld8_55:
  s_branch L_Fjoin
L_FV6:
  v_mov_b32 v10, 7044
  s_mov_b32 s15, 0
Lsp_56:
  ds_read_b32 v7, v10
  s_add_u32 s15, s15, 1
  s_waitcnt lgkmcnt(0)
  v_readfirstlane_b32 s8, v7
  s_nop 0
  s_cmp_ge_u32 s8, 4
  s_cbranch_scc1 Lspo_57
  s_cmp_lt_u32 s15, 160000
  s_cbranch_scc1 Lsp_56
Lspo_57:
  s_mov_b32 s8, 0
  s_nop 0
  buffer_load_dwordx4 v[16:19], v209, s[52:55], s8 offen offset:0 nt
  buffer_load_dwordx4 v[20:23], v209, s[52:55], s8 offen offset:1024 nt
  buffer_load_dwordx4 v[24:27], v209, s[52:55], s8 offen offset:2048 nt
  buffer_load_dwordx4 v[28:31], v209, s[52:55], s8 offen offset:3072 nt
  s_mov_b32 s8, 4096
  buffer_load_dwordx4 v[32:35], v209, s[52:55], s8 offen offset:0 nt
  buffer_load_dwordx4 v[36:39], v209, s[52:55], s8 offen offset:1024 nt
  buffer_load_dwordx4 v[40:43], v209, s[52:55], s8 offen offset:2048 nt
  buffer_load_dwordx4 v[44:47], v209, s[52:55], s8 offen offset:3072 nt
  s_mov_b32 s8, 8192
  buffer_load_dwordx4 v[48:51], v209, s[52:55], s8 offen offset:0 nt
  buffer_load_dwordx4 v[52:55], v209, s[52:55], s8 offen offset:1024 nt
  buffer_load_dwordx4 v[56:59], v209, s[52:55], s8 offen offset:2048 nt
  buffer_load_dwordx4 v[60:63], v209, s[52:55], s8 offen offset:3072 nt
  s_mov_b32 s8, 12288
  buffer_load_dwordx4 v[64:67], v209, s[52:55], s8 offen offset:0 nt
  buffer_load_dwordx4 v[68:71], v209, s[52:55], s8 offen offset:1024 nt
  buffer_load_dwordx4 v[72:75], v209, s[52:55], s8 offen offset:2048 nt
  buffer_load_dwordx4 v[76:79], v209, s[52:55], s8 offen offset:3072 nt
  s_mov_b32 s8, 16384
  buffer_load_dwordx4 v[80:83], v209, s[52:55], s8 offen offset:0 nt
  buffer_load_dwordx4 v[84:87], v209, s[52:55], s8 offen offset:1024 nt
  buffer_load_dwordx4 v[88:91], v209, s[52:55], s8 offen offset:2048 nt
  buffer_load_dwordx4 v[92:95], v209, s[52:55], s8 offen offset:3072 nt
  s_mov_b32 s8, 20480
  buffer_load_dwordx4 v[96:99], v209, s[52:55], s8 offen offset:0 nt
  buffer_load_dwordx4 v[100:103], v209, s[52:55], s8 offen offset:1024 nt
  buffer_load_dwordx4 v[104:107], v209, s[52:55], s8 offen offset:2048 nt
  buffer_load_dwordx4 v[108:111], v209, s[52:55], s8 offen offset:3072 nt
  s_waitcnt lgkmcnt(0)
  s_add_u32 s6, s7, 1
  s_and_b32 s6, s6, 0xff
  v_mov_b32 v14, s6
  s_and_b32 s9, s5, 3
  s_lshl_b32 s9, s9, 2
  s_add_u32 s9, s9, 7024
  v_mov_b32 v10, s9
  v_lshrrev_b32 v8, 4, v1
  v_lshlrev_b32 v8, 5, v8
  v_bfe_u32 v9, v1, 3, 1
  v_lshlrev_b32 v9, 4, v9
  v_add3_u32 v8, v8, v9, s27
  s_and_b32 s9, s5, 3
  s_lshl_b32 s9, s9, 10
  v_add_u32 v12, s9, v242
  s_mov_b32 s15, 0
Lsp_58:
  ds_read_b32 v7, v10
  s_add_u32 s15, s15, 1
  s_waitcnt lgkmcnt(0)
  v_readfirstlane_b32 s8, v7
  s_nop 0
  s_cmp_ge_u32 s8, 1
  s_cbranch_scc1 Lspo_59
  s_cmp_lt_u32 s15, 160000
  s_cbranch_scc1 Lsp_58
Lspo_59:
  ds_read_b128 v[112:115], v8 offset:0
  ds_read_b128 v[116:119], v8 offset:128
  ds_read_b128 v[120:123], v8 offset:256
  ds_read_b128 v[124:127], v8 offset:384
  ds_read_b128 v[128:131], v8 offset:512
  ds_read_b128 v[132:135], v8 offset:640
  s_waitcnt lgkmcnt(0)
  v_and_b32 v136, v112, v2
  v_and_b32 v137, v112, v3
  v_and_b32 v138, v112, v4
  v_and_b32 v139, v112, v5
  v_and_b32 v140, v113, v2
  v_and_b32 v141, v113, v3
  v_and_b32 v142, v113, v4
  v_and_b32 v143, v113, v5
  s_waitcnt vmcnt(20)
  v_mfma_f32_16x16x32_bf16 v[144:147], v[16:19], v[136:139], 0
  v_and_b32 v136, v114, v2
  v_and_b32 v137, v114, v3
  v_and_b32 v138, v114, v4
  v_and_b32 v139, v114, v5
  v_mfma_f32_16x16x32_bf16 v[144:147], v[20:23], v[140:143], v[144:147]
  v_and_b32 v140, v115, v2
  v_and_b32 v141, v115, v3
  v_and_b32 v142, v115, v4
  v_and_b32 v143, v115, v5
  v_mfma_f32_16x16x32_bf16 v[144:147], v[24:27], v[136:139], v[144:147]
  v_and_b32 v136, v116, v2
  v_and_b32 v137, v116, v3
  v_and_b32 v138, v116, v4
  v_and_b32 v139, v116, v5
  v_mfma_f32_16x16x32_bf16 v[144:147], v[28:31], v[140:143], v[144:147]
  v_and_b32 v140, v117, v2
  v_and_b32 v141, v117, v3
  v_and_b32 v142, v117, v4
  v_and_b32 v143, v117, v5
  s_waitcnt vmcnt(16)
  v_mfma_f32_16x16x32_bf16 v[144:147], v[32:35], v[136:139], v[144:147]
  v_and_b32 v136, v118, v2
  v_and_b32 v137, v118, v3
  v_and_b32 v138, v118, v4
  v_and_b32 v139, v118, v5
  v_mfma_f32_16x16x32_bf16 v[144:147], v[36:39], v[140:143], v[144:147]
  v_and_b32 v140, v119, v2
  v_and_b32 v141, v119, v3
  v_and_b32 v142, v119, v4
  v_and_b32 v143, v119, v5
  v_mfma_f32_16x16x32_bf16 v[144:147], v[40:43], v[136:139], v[144:147]
  v_and_b32 v136, v120, v2
  v_and_b32 v137, v120, v3
  v_and_b32 v138, v120, v4
  v_and_b32 v139, v120, v5
  v_mfma_f32_16x16x32_bf16 v[144:147], v[44:47], v[140:143], v[144:147]
  v_and_b32 v140, v121, v2
  v_and_b32 v141, v121, v3
  v_and_b32 v142, v121, v4
  v_and_b32 v143, v121, v5
  s_waitcnt vmcnt(12)
  v_mfma_f32_16x16x32_bf16 v[144:147], v[48:51], v[136:139], v[144:147]
  v_and_b32 v136, v122, v2
  v_and_b32 v137, v122, v3
  v_and_b32 v138, v122, v4
  v_and_b32 v139, v122, v5
  v_mfma_f32_16x16x32_bf16 v[144:147], v[52:55], v[140:143], v[144:147]
  v_and_b32 v140, v123, v2
  v_and_b32 v141, v123, v3
  v_and_b32 v142, v123, v4
  v_and_b32 v143, v123, v5
  v_mfma_f32_16x16x32_bf16 v[144:147], v[56:59], v[136:139], v[144:147]
  v_and_b32 v136, v124, v2
  v_and_b32 v137, v124, v3
  v_and_b32 v138, v124, v4
  v_and_b32 v139, v124, v5
  v_mfma_f32_16x16x32_bf16 v[144:147], v[60:63], v[140:143], v[144:147]
  v_and_b32 v140, v125, v2
  v_and_b32 v141, v125, v3
  v_and_b32 v142, v125, v4
  v_and_b32 v143, v125, v5
  s_waitcnt vmcnt(8)
  v_mfma_f32_16x16x32_bf16 v[144:147], v[64:67], v[136:139], v[144:147]
  v_and_b32 v136, v126, v2
  v_and_b32 v137, v126, v3
  v_and_b32 v138, v126, v4
  v_and_b32 v139, v126, v5
  v_mfma_f32_16x16x32_bf16 v[144:147], v[68:71], v[140:143], v[144:147]
  v_and_b32 v140, v127, v2
  v_and_b32 v141, v127, v3
  v_and_b32 v142, v127, v4
  v_and_b32 v143, v127, v5
  v_mfma_f32_16x16x32_bf16 v[144:147], v[72:75], v[136:139], v[144:147]
  v_and_b32 v136, v128, v2
  v_and_b32 v137, v128, v3
  v_and_b32 v138, v128, v4
  v_and_b32 v139, v128, v5
  v_mfma_f32_16x16x32_bf16 v[144:147], v[76:79], v[140:143], v[144:147]
  v_and_b32 v140, v129, v2
  v_and_b32 v141, v129, v3
  v_and_b32 v142, v129, v4
  v_and_b32 v143, v129, v5
  s_waitcnt vmcnt(4)
  v_mfma_f32_16x16x32_bf16 v[144:147], v[80:83], v[136:139], v[144:147]
  v_and_b32 v136, v130, v2
  v_and_b32 v137, v130, v3
  v_and_b32 v138, v130, v4
  v_and_b32 v139, v130, v5
  v_mfma_f32_16x16x32_bf16 v[144:147], v[84:87], v[140:143], v[144:147]
  v_and_b32 v140, v131, v2
  v_and_b32 v141, v131, v3
  v_and_b32 v142, v131, v4
  v_and_b32 v143, v131, v5
  v_mfma_f32_16x16x32_bf16 v[144:147], v[88:91], v[136:139], v[144:147]
  v_and_b32 v136, v132, v2
  v_and_b32 v137, v132, v3
  v_and_b32 v138, v132, v4
  v_and_b32 v139, v132, v5
  v_mfma_f32_16x16x32_bf16 v[144:147], v[92:95], v[140:143], v[144:147]
  v_and_b32 v140, v133, v2
  v_and_b32 v141, v133, v3
  v_and_b32 v142, v133, v4
  v_and_b32 v143, v133, v5
  s_waitcnt vmcnt(0)
  v_mfma_f32_16x16x32_bf16 v[144:147], v[96:99], v[136:139], v[144:147]
  v_and_b32 v136, v134, v2
  v_and_b32 v137, v134, v3
  v_and_b32 v138, v134, v4
  v_and_b32 v139, v134, v5
  v_mfma_f32_16x16x32_bf16 v[144:147], v[100:103], v[140:143], v[144:147]
  v_and_b32 v140, v135, v2
  v_and_b32 v141, v135, v3
  v_and_b32 v142, v135, v4
  v_and_b32 v143, v135, v5
  v_mfma_f32_16x16x32_bf16 v[144:147], v[104:107], v[136:139], v[144:147]
  s_nop 0
  v_mfma_f32_16x16x32_bf16 v[144:147], v[108:111], v[140:143], v[144:147]
  s_nop 7
  ds_write_b128 v12, v[144:147] offset:13312
  s_waitcnt lgkmcnt(0)
  v_mov_b32 v6, 7016
  v_mov_b32 v7, 1
  s_mov_b64 exec, 1
  ds_add_u32 v6, v7
  s_mov_b64 exec, -1
  s_cmp_lg_u32 s5, 7
  s_cbranch_scc1 Lpub_60
  s_mul_i32 s8, s3, 12
  s_add_u32 s8, s8, s4
  s_lshl_b32 s9, s8, 10
  s_add_u32 s9, s9, 0x20000
  v_add_u32 v9, s9, v242
  v_mov_b32 v10, 7020
  v_bfe_u32 v8, v1, 3, 1
  v_lshlrev_b32 v8, 2, v8
  s_mov_b32 s15, 0
Lsp_61:
  ds_read_b32 v7, v10
  s_add_u32 s15, s15, 1
  s_waitcnt lgkmcnt(0)
  v_readfirstlane_b32 s8, v7
  s_nop 0
  s_cmp_ge_u32 s8, 1
  s_cbranch_scc1 Lspo_62
  s_cmp_lt_u32 s15, 160000
  s_cbranch_scc1 Lsp_61
Lspo_62:
  ds_read_b32 v32, v8 offset:6976
  ds_read_b32 v33, v8 offset:6984
  ds_read_b32 v34, v8 offset:6992
  ds_read_b32 v35, v8 offset:7000
  v_mov_b32 v10, 7016
  s_mov_b32 s15, 0
Lsp_63:
  ds_read_b32 v7, v10
  s_add_u32 s15, s15, 1
  s_waitcnt lgkmcnt(0)
  v_readfirstlane_b32 s8, v7
  s_nop 0
  s_cmp_ge_u32 s8, 4
  s_cbranch_scc1 Lspo_64
  s_cmp_lt_u32 s15, 160000
  s_cbranch_scc1 Lsp_63
Lspo_64:
  ds_read_b128 v[16:19], v242 offset:13312
  ds_read_b128 v[20:23], v242 offset:14336
  ds_read_b128 v[24:27], v242 offset:15360
  ds_read_b128 v[28:31], v242 offset:16384
  s_waitcnt lgkmcnt(0)
  v_mul_f32 v16, v16, v32
  v_mul_f32 v17, v17, v32
  v_mul_f32 v18, v18, v32
  v_mul_f32 v19, v19, v32
  v_fmac_f32 v16, v20, v33
  v_fmac_f32 v17, v21, v33
  v_fmac_f32 v18, v22, v33
  v_fmac_f32 v19, v23, v33
  v_fmac_f32 v16, v24, v34
  v_fmac_f32 v17, v25, v34
  v_fmac_f32 v18, v26, v34
  v_fmac_f32 v19, v27, v34
  v_fmac_f32 v16, v28, v35
  v_fmac_f32 v17, v29, v35
  v_fmac_f32 v18, v30, v35
  v_fmac_f32 v19, v31, v35
  v_bfi_b32 v16, s14, v14, v16
  v_bfi_b32 v17, s14, v14, v17
  v_bfi_b32 v18, s14, v14, v18
  v_bfi_b32 v19, s14, v14, v19
  buffer_store_dwordx4 v[16:19], v9, s[44:47], 0 offen offset:0 sc1
  v_mov_b32 v6, 7048
  v_mov_b32 v7, 1
  s_mov_b64 exec, 1
  ds_add_u32 v6, v7
  s_mov_b64 exec, -1
Lpub_60:
  v_mov_b32 v10, 7040
  ds_read_b32 v10, v10
  s_waitcnt lgkmcnt(0)
  v_readfirstlane_b32 s96, v10
  s_mov_b32 s56, s32
  s_mov_b32 s57, s33
  s_mov_b32 s58, 0x510000
  s_mov_b32 s59, 0x00020000
  s_mov_b32 s60, 9216
  s_mov_b32 s61, 18432
  v_lshrrev_b32 v6, 3, v1
  s_mul_i32 s8, s96, 24
  v_add_u32 v6, s8, v6
  v_mul_u32_u24 v6, 1152, v6
  v_and_b32 v7, 7, v1
  v_lshlrev_b32 v7, 4, v7
  s_lshl_b32 s8, s5, 7
  v_add3_u32 v6, v6, v7, s8
  buffer_load_dwordx4 v[164:167], v6, s[56:59], 0 offen nt
  buffer_load_dwordx4 v[168:171], v6, s[56:59], s60 offen nt
  buffer_load_dwordx4 v[172:175], v6, s[56:59], s61 offen nt
  s_cmp_lg_u32 s5, 4
  s_cbranch_scc1 Ld8_65
  buffer_load_dwordx4 v[176:179], v6, s[56:59], 0 offen offset:512 nt
  buffer_load_dwordx4 v[180:183], v6, s[56:59], s60 offen offset:512 nt
  buffer_load_dwordx4 v[184:187], v6, s[56:59], s61 offen offset:512 nt
Ld8_65:
L_Fjoin:
  s_mul_i32 s8, s96, 2304
  s_add_u32 s8, s8, 0x80000
  v_add_u32 v216, s8, v240
  v_add_u32 v236, 0x9200, v13
  v_add_u32 v237, 0x8900, v13
  v_lshrrev_b32 v6, 3, v1
  v_mul_u32_u24 v233, 400, v6
  v_mul_u32_u24 v234, 400, v1
  v_lshrrev_b32 v217, 4, v1
  v_min_u32 v217, 0, v217
  v_lshlrev_b32 v217, 11, v217
  v_and_b32 v6, 15, v1
  v_lshl_add_u32 v217, v6, 4, v217
  v_mov_b32 v112, 0
  v_mov_b32 v113, 0
  v_mov_b32 v114, 0
  v_mov_b32 v115, 0
  s_cmp_ge_u32 s5, 3
  s_cbranch_scc1 Lmd_66
  v_lshlrev_b32 v204, 16, v204
  v_lshlrev_b32 v205, 16, v205
  v_lshlrev_b32 v206, 16, v206
  v_lshlrev_b32 v207, 16, v207
Lmd_66:
  v_add_u32 v235, 0x8000, v13
  v_and_b32 v6, 7, v1
  v_and_b32 v7, 3, v1
  v_min_u32 v7, 2, v7
  v_lshlrev_b32 v7, 4, v7
  v_lshrrev_b32 v8, 3, v1
  s_lshl_b32 s8, s5, 3
  v_add_u32 v8, s8, v8
  v_mul_u32_u24 v8, 9216, v8
  s_mul_i32 s8, s96, 48
  v_add3_u32 v7, v7, v8, s8
  v_mov_b32 v8, s28
  v_mov_b32 v9, s29
  v_mov_b32 v10, s30
  v_mov_b32 v12, s31
  v_cmp_lt_u32 vcc, 3, v6
  s_nop 1
  v_cndmask_b32 v8, v8, v10, vcc
  v_cndmask_b32 v9, v9, v12, vcc
  v_add_co_u32 v212, vcc, v8, v7
  s_nop 1
  v_addc_co_u32 v213, vcc, 0, v9, vcc
  s_mov_b32 s60, 589824
  s_mov_b32 s61, 0
  s_barrier
  global_load_dwordx4 v[128:131], v[212:213], off
  v_lshl_add_u64 v[212:213], v[212:213], 0, s[60:61]
  global_load_dwordx4 v[132:135], v[212:213], off
  v_lshl_add_u64 v[212:213], v[212:213], 0, s[60:61]
  global_load_dwordx4 v[136:139], v[212:213], off
  v_lshl_add_u64 v[212:213], v[212:213], 0, s[60:61]
  global_load_dwordx4 v[140:143], v[212:213], off
  v_lshl_add_u64 v[212:213], v[212:213], 0, s[60:61]
  global_load_dwordx4 v[144:147], v[212:213], off
  v_lshl_add_u64 v[212:213], v[212:213], 0, s[60:61]
  global_load_dwordx4 v[148:151], v[212:213], off
  v_lshl_add_u64 v[212:213], v[212:213], 0, s[60:61]
  global_load_dwordx4 v[152:155], v[212:213], off
  v_lshl_add_u64 v[212:213], v[212:213], 0, s[60:61]
  global_load_dwordx4 v[156:159], v[212:213], off
  v_lshl_add_u64 v[212:213], v[212:213], 0, s[60:61]
  global_load_dwordx4 v[160:163], v[212:213], off
  s_cmp_ge_u32 s5, 3
  s_cbranch_scc1 Lmi_67
  v_add_u32 v97, 0x8000, v13
  s_mov_b64 s[62:63], -1
  s_cmp_lg_u32 s5, 2
  s_cbranch_scc1 Lmp_69
  s_mov_b32 s62, 0xffff
  s_mov_b32 s63, 0
Lmp_69:
  s_mov_b64 exec, s[62:63]
  s_mov_b64 s[64:65], exec
  s_mov_b32 s15, 0
Lgr_70:
  s_mov_b64 exec, s[64:65]
  s_cbranch_execz Lgs_74
  buffer_load_dwordx4 v[80:83], v97, s[44:47], 0 offen offset:0 sc1
Lgs_74:
Lgk_72:
  s_waitcnt vmcnt(0)
Lgk1_73:
  s_mov_b64 exec, s[64:65]
  s_cbranch_execz Lgc_75
  v_xor_b32 v96, v80, v14
  v_bitop3_b32 v96, v96, v81, v14 bitop3:0xf6
  v_bitop3_b32 v96, v96, v82, v14 bitop3:0xf6
  v_bitop3_b32 v96, v96, v83, v14 bitop3:0xf6
  v_and_b32 v96, 0xff, v96
  v_cmp_ne_u32 s[64:65], 0, v96
  v_and_b32 v80, 0xffff0000, v80
  v_and_b32 v81, 0xffff0000, v81
  v_and_b32 v82, 0xffff0000, v82
  v_and_b32 v83, 0xffff0000, v83
Lgc_75:
  s_mov_b64 s[12:13], s[64:65]
  s_cmp_lg_u64 s[12:13], 0
  s_cbranch_scc0 Lgd_71
  s_add_u32 s15, s15, 1
  s_sleep 1
  s_cmp_lt_u32 s15, 20000
  s_cbranch_scc1 Lgr_70
Lgd_71:
  s_mov_b64 exec, -1
  s_branch Lmj_68
Lmi_67:
  s_cmp_ge_u32 s5, 6
  s_cbranch_scc1 Lmj_68
  v_subrev_u32 v238, 3072, v13
  v_add_u32 v97, 0x9200, v238
  v_add_u32 v98, 0x8900, v238
  s_mov_b64 s[62:63], -1
  s_cmp_lg_u32 s5, 5
  s_cbranch_scc1 Lm5_76
  s_mov_b32 s62, 0xffff
  s_mov_b32 s63, 0
Lm5_76:
  s_mov_b64 exec, s[62:63]
  s_mov_b64 s[64:65], exec
  s_mov_b64 s[66:67], exec
  s_mov_b32 s15, 0
Lgr_77:
  s_mov_b64 exec, s[64:65]
  s_cbranch_execz Lgs_81
  buffer_load_dwordx4 v[84:87], v97, s[44:47], 0 offen offset:0 sc1
Lgs_81:
  s_mov_b64 exec, s[66:67]
  s_cbranch_execz Lgs_82
  buffer_load_dwordx4 v[88:91], v98, s[44:47], 0 offen offset:0 sc1
Lgs_82:
Lgk_79:
  s_waitcnt vmcnt(0)
Lgk1_80:
  s_mov_b64 exec, s[64:65]
  s_cbranch_execz Lgc_83
  v_xor_b32 v96, v84, v14
  v_bitop3_b32 v96, v96, v85, v14 bitop3:0xf6
  v_bitop3_b32 v96, v96, v86, v14 bitop3:0xf6
  v_bitop3_b32 v96, v96, v87, v14 bitop3:0xf6
  v_and_b32 v96, 0xff, v96
  v_cmp_ne_u32 s[64:65], 0, v96
  v_and_b32 v84, 0xffff0000, v84
  v_and_b32 v85, 0xffff0000, v85
  v_and_b32 v86, 0xffff0000, v86
  v_and_b32 v87, 0xffff0000, v87
Lgc_83:
  s_mov_b64 exec, s[66:67]
  s_cbranch_execz Lgc_84
  v_xor_b32 v96, v88, v14
  v_bitop3_b32 v96, v96, v89, v14 bitop3:0xf6
  v_bitop3_b32 v96, v96, v90, v14 bitop3:0xf6
  v_bitop3_b32 v96, v96, v91, v14 bitop3:0xf6
  v_and_b32 v96, 0xff, v96
  v_cmp_ne_u32 s[66:67], 0, v96
  v_and_b32 v88, 0xffff0000, v88
  v_and_b32 v89, 0xffff0000, v89
  v_and_b32 v90, 0xffff0000, v90
  v_and_b32 v91, 0xffff0000, v91
Lgc_84:
  s_mov_b64 s[12:13], s[64:65]
  s_or_b64 s[12:13], s[12:13], s[66:67]
  s_cbranch_scc0 Lgd_78
  s_add_u32 s15, s15, 1
  s_sleep 1
  s_cmp_lt_u32 s15, 20000
  s_cbranch_scc1 Lgr_77
Lgd_78:
  s_mov_b64 exec, -1
  v_add_f32 v84, 1.0, v84
  v_add_f32 v85, 1.0, v85
  v_add_f32 v86, 1.0, v86
  v_add_f32 v87, 1.0, v87
  v_cvt_pk_bf16_f32 v100, v84, v85
  v_lshlrev_b32 v84, 16, v100
  v_and_b32 v85, 0xffff0000, v100
  v_cvt_pk_bf16_f32 v101, v86, v87
  v_lshlrev_b32 v86, 16, v101
  v_and_b32 v87, 0xffff0000, v101
  v_lshlrev_b32 v238, 1, v238
  s_mov_b64 exec, s[62:63]
  ds_write_b128 v238, v[84:87] offset:13312
  ds_write_b128 v238, v[88:91] offset:13328
  s_mov_b64 exec, -1
Lmj_68:
  s_mul_i32 s8, s5, 4608
  s_add_u32 s8, s8, 0x60000
  v_add_u32 v97, s8, v242
  v_add_u32 v98, 2304, v97
  s_mul_i32 s8, s5, 2304
  v_add_u32 v99, s8, v242
  v_mov_b32 v24, 0
  v_mov_b32 v36, 0
  v_mov_b32 v25, 0
  v_mov_b32 v37, 0
  v_mov_b32 v26, 0
  v_mov_b32 v38, 0
  v_mov_b32 v27, 0
  v_mov_b32 v39, 0
  s_mov_b64 s[64:65], -1
  s_mov_b64 s[66:67], -1
  s_mov_b32 s68, 0xffff
  s_mov_b32 s69, 0x0
  s_mov_b64 s[70:71], -1
  s_mov_b64 s[72:73], -1
  s_mov_b32 s74, 0xffff
  s_mov_b32 s75, 0x0
  s_mov_b32 s15, 0
Lgr_85:
  s_mov_b64 exec, s[64:65]
  s_cbranch_execz Lgs_89
  buffer_load_dwordx4 v[16:19], v97, s[44:47], 0 offen offset:0 sc1
Lgs_89:
  s_mov_b64 exec, s[66:67]
  s_cbranch_execz Lgs_90
  buffer_load_dwordx4 v[20:23], v97, s[44:47], 0 offen offset:1024 sc1
Lgs_90:
  s_mov_b64 exec, s[68:69]
  s_cbranch_execz Lgs_91
  buffer_load_dwordx4 v[24:27], v97, s[44:47], 0 offen offset:2048 sc1
Lgs_91:
  s_mov_b64 exec, s[70:71]
  s_cbranch_execz Lgs_92
  buffer_load_dwordx4 v[28:31], v98, s[44:47], 0 offen offset:0 sc1
Lgs_92:
  s_mov_b64 exec, s[72:73]
  s_cbranch_execz Lgs_93
  buffer_load_dwordx4 v[32:35], v98, s[44:47], 0 offen offset:1024 sc1
Lgs_93:
  s_mov_b64 exec, s[74:75]
  s_cbranch_execz Lgs_94
  buffer_load_dwordx4 v[36:39], v98, s[44:47], 0 offen offset:2048 sc1
Lgs_94:
Lgk_87:
  s_waitcnt vmcnt(0)
Lgk1_88:
  s_mov_b64 exec, s[64:65]
  s_cbranch_execz Lgc_95
  v_xor_b32 v96, v16, v14
  v_bitop3_b32 v96, v96, v17, v14 bitop3:0xf6
  v_bitop3_b32 v96, v96, v18, v14 bitop3:0xf6
  v_bitop3_b32 v96, v96, v19, v14 bitop3:0xf6
  v_and_b32 v96, 0xff, v96
  v_cmp_ne_u32 s[64:65], 0, v96
  v_and_b32 v16, 0xffffff00, v16
  v_and_b32 v17, 0xffffff00, v17
  v_and_b32 v18, 0xffffff00, v18
  v_and_b32 v19, 0xffffff00, v19
Lgc_95:
  s_mov_b64 exec, s[66:67]
  s_cbranch_execz Lgc_96
  v_xor_b32 v96, v20, v14
  v_bitop3_b32 v96, v96, v21, v14 bitop3:0xf6
  v_bitop3_b32 v96, v96, v22, v14 bitop3:0xf6
  v_bitop3_b32 v96, v96, v23, v14 bitop3:0xf6
  v_and_b32 v96, 0xff, v96
  v_cmp_ne_u32 s[66:67], 0, v96
  v_and_b32 v20, 0xffffff00, v20
  v_and_b32 v21, 0xffffff00, v21
  v_and_b32 v22, 0xffffff00, v22
  v_and_b32 v23, 0xffffff00, v23
Lgc_96:
  s_mov_b64 exec, s[68:69]
  s_cbranch_execz Lgc_97
  v_xor_b32 v96, v24, v14
  v_bitop3_b32 v96, v96, v25, v14 bitop3:0xf6
  v_bitop3_b32 v96, v96, v26, v14 bitop3:0xf6
  v_bitop3_b32 v96, v96, v27, v14 bitop3:0xf6
  v_and_b32 v96, 0xff, v96
  v_cmp_ne_u32 s[68:69], 0, v96
  v_and_b32 v24, 0xffffff00, v24
  v_and_b32 v25, 0xffffff00, v25
  v_and_b32 v26, 0xffffff00, v26
  v_and_b32 v27, 0xffffff00, v27
Lgc_97:
  s_mov_b64 exec, s[70:71]
  s_cbranch_execz Lgc_98
  v_xor_b32 v96, v28, v14
  v_bitop3_b32 v96, v96, v29, v14 bitop3:0xf6
  v_bitop3_b32 v96, v96, v30, v14 bitop3:0xf6
  v_bitop3_b32 v96, v96, v31, v14 bitop3:0xf6
  v_and_b32 v96, 0xff, v96
  v_cmp_ne_u32 s[70:71], 0, v96
  v_and_b32 v28, 0xffffff00, v28
  v_and_b32 v29, 0xffffff00, v29
  v_and_b32 v30, 0xffffff00, v30
  v_and_b32 v31, 0xffffff00, v31
Lgc_98:
  s_mov_b64 exec, s[72:73]
  s_cbranch_execz Lgc_99
  v_xor_b32 v96, v32, v14
  v_bitop3_b32 v96, v96, v33, v14 bitop3:0xf6
  v_bitop3_b32 v96, v96, v34, v14 bitop3:0xf6
  v_bitop3_b32 v96, v96, v35, v14 bitop3:0xf6
  v_and_b32 v96, 0xff, v96
  v_cmp_ne_u32 s[72:73], 0, v96
  v_and_b32 v32, 0xffffff00, v32
  v_and_b32 v33, 0xffffff00, v33
  v_and_b32 v34, 0xffffff00, v34
  v_and_b32 v35, 0xffffff00, v35
Lgc_99:
  s_mov_b64 exec, s[74:75]
  s_cbranch_execz Lgc_100
  v_xor_b32 v96, v36, v14
  v_bitop3_b32 v96, v96, v37, v14 bitop3:0xf6
  v_bitop3_b32 v96, v96, v38, v14 bitop3:0xf6
  v_bitop3_b32 v96, v96, v39, v14 bitop3:0xf6
  v_and_b32 v96, 0xff, v96
  v_cmp_ne_u32 s[74:75], 0, v96
  v_and_b32 v36, 0xffffff00, v36
  v_and_b32 v37, 0xffffff00, v37
  v_and_b32 v38, 0xffffff00, v38
  v_and_b32 v39, 0xffffff00, v39
Lgc_100:
  s_mov_b64 s[12:13], s[64:65]
  s_or_b64 s[12:13], s[12:13], s[66:67]
  s_or_b64 s[12:13], s[12:13], s[68:69]
  s_or_b64 s[12:13], s[12:13], s[70:71]
  s_or_b64 s[12:13], s[12:13], s[72:73]
  s_or_b64 s[12:13], s[12:13], s[74:75]
  s_cbranch_scc0 Lgd_86
  s_add_u32 s15, s15, 1
  s_sleep 1
  s_cmp_lt_u32 s15, 20000
  s_cbranch_scc1 Lgr_85
Lgd_86:
  s_mov_b64 exec, -1
  v_pk_add_f32 v[16:17], v[16:17], v[28:29]
  v_pk_add_f32 v[18:19], v[18:19], v[30:31]
  v_pk_add_f32 v[20:21], v[20:21], v[32:33]
  v_pk_add_f32 v[22:23], v[22:23], v[34:35]
  v_pk_add_f32 v[24:25], v[24:25], v[36:37]
  v_pk_add_f32 v[26:27], v[26:27], v[38:39]
  ds_write_b128 v99, v[16:19] offset:24576
  ds_write_b128 v99, v[20:23] offset:25600
  s_mov_b32 exec_lo, 0xffff
  s_mov_b32 exec_hi, 0x0
  ds_write_b128 v99, v[24:27] offset:26624
  s_mov_b64 exec, -1
  s_waitcnt lgkmcnt(0)
  s_barrier
  s_cmp_ge_u32 s5, 3
  s_cbranch_scc1 Lx1_101
  s_mov_b64 exec, -1
  s_cmp_lg_u32 s5, 2
  s_cbranch_scc1 Lx_102
  s_mov_b32 exec_lo, 0xffff
  s_mov_b32 exec_hi, 0x0
Lx_102:
  v_lshlrev_b32 v238, 1, v13
  ds_read_b128 v[84:87], v238 offset:13312
  ds_read_b128 v[88:91], v238 offset:13328
  ds_read_b128 v[16:19], v13 offset:24576
  ds_read_b128 v[20:23], v13 offset:26880
  ds_read_b128 v[24:27], v13 offset:29184
  ds_read_b128 v[28:31], v13 offset:31488
  ds_read_b128 v[32:35], v13 offset:33792
  ds_read_b128 v[36:39], v13 offset:36096
  ds_read_b128 v[40:43], v13 offset:38400
  ds_read_b128 v[44:47], v13 offset:40704
  s_waitcnt lgkmcnt(0)
  v_pk_add_f32 v[16:17], v[16:17], v[20:21]
  v_pk_add_f32 v[18:19], v[18:19], v[22:23]
  v_pk_add_f32 v[24:25], v[24:25], v[28:29]
  v_pk_add_f32 v[26:27], v[26:27], v[30:31]
  v_pk_add_f32 v[32:33], v[32:33], v[36:37]
  v_pk_add_f32 v[34:35], v[34:35], v[38:39]
  v_pk_add_f32 v[40:41], v[40:41], v[44:45]
  v_pk_add_f32 v[42:43], v[42:43], v[46:47]
  v_pk_add_f32 v[16:17], v[16:17], v[24:25]
  v_pk_add_f32 v[18:19], v[18:19], v[26:27]
  v_pk_add_f32 v[32:33], v[32:33], v[40:41]
  v_pk_add_f32 v[34:35], v[34:35], v[42:43]
  v_pk_add_f32 v[16:17], v[16:17], v[32:33]
  v_pk_add_f32 v[18:19], v[18:19], v[34:35]
  v_cvt_pk_bf16_f32 v96, v16, v17
  v_lshlrev_b32 v16, 16, v96
  v_and_b32 v17, 0xffff0000, v96
  v_cvt_pk_bf16_f32 v97, v18, v19
  v_lshlrev_b32 v18, 16, v97
  v_and_b32 v19, 0xffff0000, v97
  v_mul_f32 v16, v80, v16
  v_mul_f32 v17, v81, v17
  v_mul_f32 v18, v82, v18
  v_mul_f32 v19, v83, v19
  v_cvt_pk_bf16_f32 v96, v16, v17
  v_lshlrev_b32 v16, 16, v96
  v_and_b32 v17, 0xffff0000, v96
  v_cvt_pk_bf16_f32 v97, v18, v19
  v_lshlrev_b32 v18, 16, v97
  v_and_b32 v19, 0xffff0000, v97
  v_add_f32 v112, v204, v16
  v_add_f32 v113, v205, v17
  v_add_f32 v114, v206, v18
  v_add_f32 v115, v207, v19
  v_cvt_pk_bf16_f32 v96, v112, v113
  v_lshlrev_b32 v112, 16, v96
  v_and_b32 v113, 0xffff0000, v96
  v_cvt_pk_bf16_f32 v97, v114, v115
  v_lshlrev_b32 v114, 16, v97
  v_and_b32 v115, 0xffff0000, v97
  s_mov_b64 exec, -1
  v_add_f32 v96, v112, v113
  v_mul_f32 v97, v112, v112
  v_add_f32 v96, v96, v114
  v_fmac_f32 v97, v113, v113
  v_add_f32 v96, v96, v115
  v_fmac_f32 v97, v114, v114
  v_fmac_f32 v97, v115, v115
  v_add_f32_dpp v96, v96, v96 row_shr:1 row_mask:0xf bank_mask:0xf
  s_nop 0
  v_add_f32_dpp v97, v97, v97 row_shr:1 row_mask:0xf bank_mask:0xf
  v_add_f32_dpp v96, v96, v96 row_shr:2 row_mask:0xf bank_mask:0xf
  s_nop 0
  v_add_f32_dpp v97, v97, v97 row_shr:2 row_mask:0xf bank_mask:0xf
  v_add_f32_dpp v96, v96, v96 row_shr:4 row_mask:0xf bank_mask:0xf
  s_nop 0
  v_add_f32_dpp v97, v97, v97 row_shr:4 row_mask:0xf bank_mask:0xf
  v_add_f32_dpp v96, v96, v96 row_shr:8 row_mask:0xf bank_mask:0xf
  s_nop 0
  v_add_f32_dpp v97, v97, v97 row_shr:8 row_mask:0xf bank_mask:0xf
  v_add_f32_dpp v96, v96, v96 row_bcast:15 row_mask:0xa bank_mask:0xf
  s_nop 0
  v_add_f32_dpp v97, v97, v97 row_bcast:15 row_mask:0xa bank_mask:0xf
  v_add_f32_dpp v96, v96, v96 row_bcast:31 row_mask:0xc bank_mask:0xf
  s_nop 0
  v_add_f32_dpp v97, v97, v97 row_bcast:31 row_mask:0xc bank_mask:0xf
  s_lshl_b32 s8, s5, 3
  s_add_u32 s8, s8, 7056
  v_mov_b32 v98, s8
  s_mov_b32 exec_lo, 0
  s_mov_b32 exec_hi, 0x80000000
  ds_write_b64 v98, v[96:97]
  s_mov_b64 exec, -1
Lx1_101:
  s_waitcnt lgkmcnt(0)
  s_barrier
  s_cmp_ge_u32 s5, 3
  s_cbranch_scc1 Lh2_103
  v_mov_b32 v96, 7056
  ds_read_b128 v[100:103], v96
  ds_read_b64 v[98:99], v96 offset:16
  s_waitcnt lgkmcnt(0)
  v_pk_add_f32 v[96:97], v[100:101], v[102:103]
  v_pk_add_f32 v[96:97], v[96:97], v[98:99]
  v_mul_f32 v96, 0x3ae38e39, v96
  v_mul_f32 v97, 0x3ae38e39, v97
  v_fma_f32 v97, -v96, v96, v97
  v_max_f32 v97, 0, v97
  v_cvt_pk_bf16_f32 v98, v96, v97
  v_lshlrev_b32 v96, 16, v98
  v_and_b32 v97, 0xffff0000, v98
  v_add_f32 v97, 0x3727c5ac, v97
  v_sub_f32 v104, v112, v96
  v_sub_f32 v105, v113, v96
  v_sub_f32 v106, v114, v96
  v_sub_f32 v107, v115, v96
  v_cvt_pk_bf16_f32 v97, v97, v97
  v_and_b32 v97, 0xffff0000, v97
  v_sqrt_f32 v97, v97
  v_cvt_pk_bf16_f32 v98, v104, v105
  v_lshlrev_b32 v104, 16, v98
  v_and_b32 v105, 0xffff0000, v98
  v_cvt_pk_bf16_f32 v99, v106, v107
  v_lshlrev_b32 v106, 16, v99
  v_and_b32 v107, 0xffff0000, v99
  v_cvt_pk_bf16_f32 v97, v97, v97
  v_and_b32 v97, 0xffff0000, v97
  v_rcp_f32 v97, v97
  s_nop 0
  v_mul_f32 v104, v104, v97
  v_mul_f32 v105, v105, v97
  v_mul_f32 v106, v106, v97
  v_mul_f32 v107, v107, v97
  v_cvt_pk_bf16_f32 v98, v104, v105
  v_lshlrev_b32 v104, 16, v98
  v_and_b32 v105, 0xffff0000, v98
  v_cvt_pk_bf16_f32 v99, v106, v107
  v_lshlrev_b32 v106, 16, v99
  v_and_b32 v107, 0xffff0000, v99
  v_mul_f32 v104, v104, v84
  v_mul_f32 v105, v105, v85
  v_mul_f32 v106, v106, v86
  v_mul_f32 v107, v107, v87
  v_cvt_pk_bf16_f32 v96, v104, v105
  v_lshlrev_b32 v104, 16, v96
  v_and_b32 v105, 0xffff0000, v96
  v_cvt_pk_bf16_f32 v97, v106, v107
  v_lshlrev_b32 v106, 16, v97
  v_and_b32 v107, 0xffff0000, v97
  v_add_f32 v104, v104, v88
  v_add_f32 v105, v105, v89
  v_add_f32 v106, v106, v90
  v_add_f32 v107, v107, v91
  v_cvt_pk_bf16_f32 v104, v104, v104
  v_cvt_pk_bf16_f32 v105, v105, v105
  v_cvt_pk_bf16_f32 v106, v106, v106
  v_cvt_pk_bf16_f32 v107, v107, v107
  s_mov_b64 exec, -1
  s_cmp_lg_u32 s5, 2
  s_cbranch_scc1 Lx_104
  s_mov_b32 exec_lo, 0xffff
  s_mov_b32 exec_hi, 0x0
Lx_104:
  ds_write_b32 v15, v104 offset:0
  ds_write_b32 v15, v105 offset:48
  ds_write_b32 v15, v106 offset:96
  ds_write_b32 v15, v107 offset:144
  s_mov_b64 exec, -1
Lh2_103:
  s_waitcnt lgkmcnt(0)
  s_barrier
  ds_read_b128 v[16:19], v241 offset:0
  ds_read_b128 v[20:23], v241 offset:16
  ds_read_b128 v[24:27], v241 offset:32
  s_waitcnt vmcnt(0) lgkmcnt(0)
  v_and_b32 v36, v16, v2
  v_and_b32 v37, v16, v3
  v_and_b32 v38, v16, v4
  v_and_b32 v39, v16, v5
  v_and_b32 v40, v17, v2
  v_and_b32 v41, v17, v3
  v_and_b32 v42, v17, v4
  v_and_b32 v43, v17, v5
  v_mfma_f32_16x16x32_bf16 v[32:35], v[128:131], v[36:39], 0
  v_and_b32 v36, v18, v2
  v_and_b32 v37, v18, v3
  v_and_b32 v38, v18, v4
  v_and_b32 v39, v18, v5
  v_mfma_f32_16x16x32_bf16 v[32:35], v[132:135], v[40:43], v[32:35]
  v_and_b32 v40, v19, v2
  v_and_b32 v41, v19, v3
  v_and_b32 v42, v19, v4
  v_and_b32 v43, v19, v5
  v_mfma_f32_16x16x32_bf16 v[32:35], v[136:139], v[36:39], v[32:35]
  v_and_b32 v36, v20, v2
  v_and_b32 v37, v20, v3
  v_and_b32 v38, v20, v4
  v_and_b32 v39, v20, v5
  v_mfma_f32_16x16x32_bf16 v[32:35], v[140:143], v[40:43], v[32:35]
  v_and_b32 v40, v21, v2
  v_and_b32 v41, v21, v3
  v_and_b32 v42, v21, v4
  v_and_b32 v43, v21, v5
  v_mfma_f32_16x16x32_bf16 v[32:35], v[144:147], v[36:39], v[32:35]
  v_and_b32 v36, v22, v2
  v_and_b32 v37, v22, v3
  v_and_b32 v38, v22, v4
  v_and_b32 v39, v22, v5
  v_mfma_f32_16x16x32_bf16 v[32:35], v[148:151], v[40:43], v[32:35]
  v_and_b32 v40, v23, v2
  v_and_b32 v41, v23, v3
  v_and_b32 v42, v23, v4
  v_and_b32 v43, v23, v5
  v_mfma_f32_16x16x32_bf16 v[32:35], v[152:155], v[36:39], v[32:35]
  v_and_b32 v36, v24, v2
  v_and_b32 v37, v24, v3
  v_and_b32 v38, v24, v4
  v_and_b32 v39, v24, v5
  v_mfma_f32_16x16x32_bf16 v[32:35], v[156:159], v[40:43], v[32:35]
  s_nop 0
  v_mfma_f32_16x16x32_bf16 v[32:35], v[160:163], v[36:39], v[32:35]
  s_nop 7
  v_mov_b32 v36, v32
  v_mov_b32 v37, v33
  v_mov_b32 v38, v34
  v_mov_b32 v39, v35
  v_permlane32_swap_b32 v36, v32
  v_permlane32_swap_b32 v37, v33
  v_permlane32_swap_b32 v38, v34
  v_permlane32_swap_b32 v39, v35
  v_add_f32_dpp v32, v32, v36 row_ror:8 row_mask:0xf bank_mask:0xf
  v_add_f32_dpp v33, v33, v37 row_ror:8 row_mask:0xf bank_mask:0xf
  v_add_f32_dpp v34, v34, v38 row_ror:8 row_mask:0xf bank_mask:0xf
  v_add_f32_dpp v35, v35, v39 row_ror:8 row_mask:0xf bank_mask:0xf
  s_mov_b32 exec_lo, 0xff00ff
  s_mov_b32 exec_hi, 0x0
  ds_write_b128 v240, v[32:35] offset:7168
  s_mov_b64 exec, -1
  s_waitcnt lgkmcnt(0)
  s_barrier
  s_cmp_lg_u32 s5, 0
  s_cbranch_scc1 Lact_105
  ds_read_b128 v[40:43], v217 offset:7168
  ds_read_b128 v[44:47], v217 offset:7424
  ds_read_b128 v[48:51], v217 offset:7680
  ds_read_b128 v[52:55], v217 offset:7936
  ds_read_b128 v[56:59], v217 offset:8192
  ds_read_b128 v[60:63], v217 offset:8448
  ds_read_b128 v[64:67], v217 offset:8704
  ds_read_b128 v[68:71], v217 offset:8960
  s_waitcnt lgkmcnt(0)
  v_pk_add_f32 v[40:41], v[40:41], v[44:45]
  v_pk_add_f32 v[42:43], v[42:43], v[46:47]
  v_pk_add_f32 v[48:49], v[48:49], v[52:53]
  v_pk_add_f32 v[50:51], v[50:51], v[54:55]
  v_pk_add_f32 v[56:57], v[56:57], v[60:61]
  v_pk_add_f32 v[58:59], v[58:59], v[62:63]
  v_pk_add_f32 v[64:65], v[64:65], v[68:69]
  v_pk_add_f32 v[66:67], v[66:67], v[70:71]
  v_pk_add_f32 v[40:41], v[40:41], v[48:49]
  v_pk_add_f32 v[42:43], v[42:43], v[50:51]
  v_pk_add_f32 v[56:57], v[56:57], v[64:65]
  v_pk_add_f32 v[58:59], v[58:59], v[66:67]
  v_pk_add_f32 v[40:41], v[40:41], v[56:57]
  v_pk_add_f32 v[42:43], v[42:43], v[58:59]
  v_cvt_pk_bf16_f32 v52, v40, v41
  v_lshlrev_b32 v40, 16, v52
  v_and_b32 v41, 0xffff0000, v52
  v_cvt_pk_bf16_f32 v42, v42, v42
  v_and_b32 v42, 0xffff0000, v42
  v_mov_b32_dpp v44, v40 row_ror:8 row_mask:0xf bank_mask:0xf
  v_mov_b32_dpp v45, v41 row_ror:8 row_mask:0xf bank_mask:0xf
  v_mov_b32_dpp v46, v42 row_ror:8 row_mask:0xf bank_mask:0xf
  v_mul_f32 v48, v40, v40
  v_mul_f32 v49, v41, v41
  v_mul_f32 v50, v42, v42
  v_mul_f32 v48, 0x3d372713, v48
  v_mul_f32 v49, 0x3d372713, v49
  v_mul_f32 v50, 0x3d372713, v50
  v_fma_f32 v48, v48, v40, v40
  v_fma_f32 v49, v49, v41, v41
  v_fma_f32 v50, v50, v42, v42
  v_mul_f32 v48, 0xc0135761, v48
  v_mul_f32 v49, 0xc0135761, v49
  v_mul_f32 v50, 0xc0135761, v50
  v_exp_f32 v48, v48
  v_exp_f32 v49, v49
  v_exp_f32 v50, v50
  v_add_f32 v48, 1.0, v48
  v_add_f32 v49, 1.0, v49
  v_add_f32 v50, 1.0, v50
  v_rcp_f32 v48, v48
  v_rcp_f32 v49, v49
  v_rcp_f32 v50, v50
  v_mul_f32 v48, v40, v48
  v_mul_f32 v49, v41, v49
  v_mul_f32 v50, v42, v50
  v_cvt_pk_bf16_f32 v52, v48, v49
  v_lshlrev_b32 v48, 16, v52
  v_and_b32 v49, 0xffff0000, v52
  v_cvt_pk_bf16_f32 v50, v50, v50
  v_and_b32 v50, 0xffff0000, v50
  v_mul_f32 v48, v48, v44
  v_mul_f32 v49, v49, v45
  v_mul_f32 v50, v50, v46
  v_cvt_pk_bf16_f32 v48, v48, v48
  v_cvt_pk_bf16_f32 v49, v49, v49
  v_cvt_pk_bf16_f32 v50, v50, v50
  s_mov_b32 exec_lo, 0xff
  s_mov_b32 exec_hi, 0x0
  ds_write_b32 v234, v48 offset:3200
  ds_write_b32 v234, v49 offset:3248
  ds_write_b32 v234, v50 offset:3296
  s_mov_b64 exec, -1
Lact_105:
  s_waitcnt lgkmcnt(0)
  s_barrier
  ds_read_b32 v16, v233 offset:3200
  ds_read_b32 v17, v233 offset:3248
  ds_read_b32 v18, v233 offset:3296
  s_waitcnt lgkmcnt(0)
  v_and_b32 v36, v16, v2
  v_and_b32 v37, v16, v3
  v_and_b32 v38, v16, v4
  v_and_b32 v39, v16, v5
  v_and_b32 v40, v17, v2
  v_and_b32 v41, v17, v3
  v_and_b32 v42, v17, v4
  v_and_b32 v43, v17, v5
  v_mfma_f32_16x16x32_bf16 v[32:35], v[164:167], v[36:39], 0
  v_and_b32 v36, v18, v2
  v_and_b32 v37, v18, v3
  v_and_b32 v38, v18, v4
  v_and_b32 v39, v18, v5
  v_mfma_f32_16x16x32_bf16 v[32:35], v[168:171], v[40:43], v[32:35]
  s_nop 0
  v_mfma_f32_16x16x32_bf16 v[32:35], v[172:175], v[36:39], v[32:35]
  s_nop 7
  v_mov_b32 v36, v32
  v_mov_b32 v37, v33
  v_mov_b32 v38, v34
  v_mov_b32 v39, v35
  v_permlane32_swap_b32 v36, v32
  v_permlane32_swap_b32 v37, v33
  v_permlane32_swap_b32 v38, v34
  v_permlane32_swap_b32 v39, v35
  v_add_f32_dpp v32, v32, v36 row_ror:8 row_mask:0xf bank_mask:0xf
  v_add_f32_dpp v33, v33, v37 row_ror:8 row_mask:0xf bank_mask:0xf
  v_add_f32_dpp v34, v34, v38 row_ror:8 row_mask:0xf bank_mask:0xf
  v_add_f32_dpp v35, v35, v39 row_ror:8 row_mask:0xf bank_mask:0xf
  v_bfi_b32 v32, s14, v14, v32
  v_bfi_b32 v33, s14, v14, v33
  v_bfi_b32 v34, s14, v14, v34
  v_bfi_b32 v35, s14, v14, v35
  s_mov_b32 exec_lo, 0xff00ff
  s_mov_b32 exec_hi, 0x0
  buffer_store_dwordx4 v[32:35], v216, s[44:47], 0 offen offset:0 sc1
  s_mov_b64 exec, -1
  s_cmp_lg_u32 s5, 4
  s_cbranch_scc1 L_Fend
  v_and_b32 v36, v16, v2
  v_and_b32 v37, v16, v3
  v_and_b32 v38, v16, v4
  v_and_b32 v39, v16, v5
  v_and_b32 v40, v17, v2
  v_and_b32 v41, v17, v3
  v_and_b32 v42, v17, v4
  v_and_b32 v43, v17, v5
  v_mfma_f32_16x16x32_bf16 v[44:47], v[176:179], v[36:39], 0
  v_and_b32 v36, v18, v2
  v_and_b32 v37, v18, v3
  v_and_b32 v38, v18, v4
  v_and_b32 v39, v18, v5
  v_mfma_f32_16x16x32_bf16 v[44:47], v[180:183], v[40:43], v[44:47]
  s_nop 0
  v_mfma_f32_16x16x32_bf16 v[44:47], v[184:187], v[36:39], v[44:47]
  s_nop 7
  v_mov_b32 v36, v44
  v_mov_b32 v37, v45
  v_mov_b32 v38, v46
  v_mov_b32 v39, v47
  v_permlane32_swap_b32 v36, v44
  v_permlane32_swap_b32 v37, v45
  v_permlane32_swap_b32 v38, v46
  v_permlane32_swap_b32 v39, v47
  v_add_f32_dpp v44, v44, v36 row_ror:8 row_mask:0xf bank_mask:0xf
  v_add_f32_dpp v45, v45, v37 row_ror:8 row_mask:0xf bank_mask:0xf
  v_add_f32_dpp v46, v46, v38 row_ror:8 row_mask:0xf bank_mask:0xf
  v_add_f32_dpp v47, v47, v39 row_ror:8 row_mask:0xf bank_mask:0xf
  v_bfi_b32 v44, s14, v14, v44
  v_bfi_b32 v45, s14, v14, v45
  v_bfi_b32 v46, s14, v14, v46
  v_bfi_b32 v47, s14, v14, v47
  s_mov_b32 exec_lo, 0xff00ff
  s_mov_b32 exec_hi, 0x0
  buffer_store_dwordx4 v[44:47], v216, s[44:47], 0 offen offset:1024 sc1
  s_mov_b64 exec, -1
L_Fend:
  s_endpgm
L_S:
  s_sub_u32 s8, s2, 192
  s_and_b32 s9, s8, 7
  s_lshr_b32 s10, s8, 3
  s_lshl_b32 s98, s9, 3
  s_add_u32 s98, s98, s10
  s_lshr_b32 s4, s98, 2
  s_and_b32 s97, s98, 3
  s_mul_i32 s3, s4, 3
  s_add_u32 s3, s3, s97
  s_add_u32 s8, s4, 48
  s_cmp_eq_u32 s97, 3
  s_cselect_b32 s3, s8, s3
  v_lshrrev_b32 v8, 3, v1
  s_lshl_b32 s11, s5, 3
  v_add_u32 v8, s11, v8
  v_lshlrev_b32 v248, 1, v8
  s_lshl_b32 s8, s98, 7
  v_lshrrev_b32 v6, 3, v1
  s_lshl_b32 s11, s5, 3
  v_add_u32 v6, s11, v6
  v_mul_u32_u24 v6, 8192, v6
  v_and_b32 v7, 7, v1
  v_lshlrev_b32 v7, 4, v7
  v_add3_u32 v244, v6, v7, s8
  s_waitcnt lgkmcnt(0)
  s_mov_b32 s52, s22
  s_mov_b32 s53, s23
  s_mov_b32 s54, 0x480000
  s_mov_b32 s55, 0x00020000
  v_add_u32 v6, 0, v244
  buffer_load_dwordx4 v[28:31], v6, s[52:55], 0 offen nt
  v_add_u32 v6, 524288, v244
  buffer_load_dwordx4 v[32:35], v6, s[52:55], 0 offen nt
  v_add_u32 v6, 1048576, v244
  buffer_load_dwordx4 v[36:39], v6, s[52:55], 0 offen nt
  v_add_u32 v6, 1572864, v244
  buffer_load_dwordx4 v[40:43], v6, s[52:55], 0 offen nt
  v_add_u32 v6, 2097152, v244
  buffer_load_dwordx4 v[44:47], v6, s[52:55], 0 offen nt
  v_add_u32 v6, 2621440, v244
  buffer_load_dwordx4 v[48:51], v6, s[52:55], 0 offen nt
  v_add_u32 v6, 3145728, v244
  buffer_load_dwordx4 v[52:55], v6, s[52:55], 0 offen nt
  s_load_dword s7, s[42:43], 0
  s_mov_b32 s48, s36
  s_mov_b32 s49, s37
  s_mov_b32 s50, 0x3cc000
  s_mov_b32 s51, 0x00020000
  s_mov_b32 s44, s42
  s_mov_b32 s45, s43
  s_mov_b32 s46, 0x400000
  s_mov_b32 s47, 0x00020000
  v_lshlrev_b32 v13, 4, v0
  v_and_b32 v6, 7, v0
  v_bfe_u32 v7, v0, 3, 1
  v_lshrrev_b32 v8, 4, v0
  v_mul_u32_u24 v15, 400, v6
  v_mul_u32_u24 v9, 192, v7
  v_lshlrev_b32 v10, 2, v8
  v_add3_u32 v15, v15, v9, v10
  v_lshlrev_b32 v11, 7, v8
  v_lshlrev_b32 v9, 6, v7
  v_lshlrev_b32 v10, 1, v6
  v_add3_u32 v11, v11, v9, v10
  v_mov_b32 v152, 0
  v_mov_b32 v153, 0
  v_mov_b32 v154, 0
  v_mov_b32 v155, 0
  s_cmp_ge_u32 s5, 3
  s_cbranch_scc1 Lsx_106
  s_mov_b32 s56, s16
  s_mov_b32 s57, s17
  s_mov_b32 s58, 0x480
  s_mov_b32 s59, 0x00020000
  s_mov_b64 exec, -1
  s_cmp_lg_u32 s5, 2
  s_cbranch_scc1 Lx_107
  s_mov_b32 exec_lo, 0xffff
  s_mov_b32 exec_hi, 0x0
Lx_107:
  buffer_load_ushort v152, v11, s[56:59], 0 offen offset:0
  buffer_load_ushort v153, v11, s[56:59], 0 offen offset:16
  buffer_load_ushort v154, v11, s[56:59], 0 offen offset:32
  buffer_load_ushort v155, v11, s[56:59], 0 offen offset:48
  s_mov_b64 exec, -1
Lsx_106:
  v_and_b32 v6, 1, v1
  v_mov_b32 v7, 0xffff0000
  v_mov_b32 v8, 0xffff
  v_cmp_eq_u32 vcc, 1, v6
  v_bfe_u32 v6, v1, 1, 2
  s_nop 0
  v_cndmask_b32 v9, v8, v7, vcc
  v_cmp_eq_u32 vcc, 0, v6
  s_nop 1
  v_cndmask_b32 v2, 0, v9, vcc
  v_cmp_eq_u32 vcc, 1, v6
  s_nop 1
  v_cndmask_b32 v3, 0, v9, vcc
  v_cmp_eq_u32 vcc, 2, v6
  s_nop 1
  v_cndmask_b32 v4, 0, v9, vcc
  v_cmp_eq_u32 vcc, 3, v6
  s_nop 1
  v_cndmask_b32 v5, 0, v9, vcc
  v_and_b32 v6, 7, v1
  v_bfe_u32 v7, v1, 4, 1
  v_lshl_add_u32 v6, v7, 3, v6
  v_lshlrev_b32 v6, 4, v6
  s_lshl_b32 s8, s5, 8
  v_add_u32 v240, s8, v6
  v_lshrrev_b32 v6, 3, v1
  v_mul_u32_u24 v6, 400, v6
  s_mul_i32 s8, s5, 48
  v_add_u32 v241, s8, v6
  v_lshlrev_b32 v242, 4, v1
  v_lshrrev_b32 v247, 4, v1
  v_min_u32 v247, 2, v247
  v_lshlrev_b32 v247, 11, v247
  v_and_b32 v6, 15, v1
  v_lshl_add_u32 v247, v6, 4, v247
  s_waitcnt vmcnt(6)
  v_add_u32 v6, 3670016, v244
  buffer_load_dwordx4 v[56:59], v6, s[52:55], 0 offen nt
  s_waitcnt vmcnt(6)
  v_add_u32 v6, 4194304, v244
  buffer_load_dwordx4 v[60:63], v6, s[52:55], 0 offen nt
  s_lshl_b32 s8, s4, 8
  s_and_b32 s9, s5, 1
  s_lshl_b32 s9, s9, 7
  s_add_u32 s8, s8, s9
  s_lshr_b32 s9, s5, 1
  s_lshl_b32 s9, s9, 5
  s_add_u32 s8, s8, s9
  s_mul_i32 s8, s8, 1152
  s_min_u32 s9, s97, 2
  s_mul_i32 s9, s9, 384
  s_add_u32 s8, s8, s9
  v_lshrrev_b32 v6, 3, v1
  v_mul_u32_u24 v6, 1152, v6
  v_and_b32 v7, 7, v1
  v_lshlrev_b32 v7, 4, v7
  v_add3_u32 v245, v6, v7, s8
  s_mov_b32 s60, 9216
  s_mov_b32 s61, 18432
  s_mov_b32 s62, 27648
  s_waitcnt lgkmcnt(0)
  s_add_u32 s6, s7, 1
  s_and_b32 s6, s6, 0xff
  v_mov_b32 v14, s6
  s_cmp_ge_u32 s5, 3
  s_cbranch_scc1 Lsi_108
  s_waitcnt vmcnt(2)
  v_lshlrev_b32 v152, 16, v152
  v_lshlrev_b32 v153, 16, v153
  v_lshlrev_b32 v154, 16, v154
  v_lshlrev_b32 v155, 16, v155
  v_add_f32 v184, v152, v153
  v_mul_f32 v185, v152, v152
  v_add_f32 v184, v184, v154
  v_fmac_f32 v185, v153, v153
  v_add_f32 v184, v184, v155
  v_fmac_f32 v185, v154, v154
  v_fmac_f32 v185, v155, v155
  v_add_f32_dpp v184, v184, v184 row_shr:1 row_mask:0xf bank_mask:0xf
  s_nop 0
  v_add_f32_dpp v185, v185, v185 row_shr:1 row_mask:0xf bank_mask:0xf
  v_add_f32_dpp v184, v184, v184 row_shr:2 row_mask:0xf bank_mask:0xf
  s_nop 0
  v_add_f32_dpp v185, v185, v185 row_shr:2 row_mask:0xf bank_mask:0xf
  v_add_f32_dpp v184, v184, v184 row_shr:4 row_mask:0xf bank_mask:0xf
  s_nop 0
  v_add_f32_dpp v185, v185, v185 row_shr:4 row_mask:0xf bank_mask:0xf
  v_add_f32_dpp v184, v184, v184 row_shr:8 row_mask:0xf bank_mask:0xf
  s_nop 0
  v_add_f32_dpp v185, v185, v185 row_shr:8 row_mask:0xf bank_mask:0xf
  v_add_f32_dpp v184, v184, v184 row_bcast:15 row_mask:0xa bank_mask:0xf
  s_nop 0
  v_add_f32_dpp v185, v185, v185 row_bcast:15 row_mask:0xa bank_mask:0xf
  v_add_f32_dpp v184, v184, v184 row_bcast:31 row_mask:0xc bank_mask:0xf
  s_nop 0
  v_add_f32_dpp v185, v185, v185 row_bcast:31 row_mask:0xc bank_mask:0xf
  s_lshl_b32 s8, s5, 3
  s_add_u32 s8, s8, 7056
  v_mov_b32 v186, s8
  s_mov_b32 exec_lo, 0
  s_mov_b32 exec_hi, 0x80000000
  ds_write_b64 v186, v[184:185]
  s_mov_b64 exec, -1
Lsi_108:
  s_waitcnt lgkmcnt(0)
  s_barrier
  s_cmp_ge_u32 s5, 3
  s_cbranch_scc1 Lh0_109
  v_mov_b32 v184, 7056
  ds_read_b128 v[188:191], v184
  ds_read_b64 v[186:187], v184 offset:16
  s_waitcnt lgkmcnt(0)
  v_pk_add_f32 v[184:185], v[188:189], v[190:191]
  v_pk_add_f32 v[184:185], v[184:185], v[186:187]
  v_mul_f32 v184, 0x3ae38e39, v184
  v_mul_f32 v185, 0x3ae38e39, v185
  v_fma_f32 v185, -v184, v184, v185
  v_max_f32 v185, 0, v185
  v_cvt_pk_bf16_f32 v186, v184, v185
  v_lshlrev_b32 v184, 16, v186
  v_and_b32 v185, 0xffff0000, v186
  v_add_f32 v185, 0x3727c5ac, v185
  v_sub_f32 v156, v152, v184
  v_sub_f32 v157, v153, v184
  v_sub_f32 v158, v154, v184
  v_sub_f32 v159, v155, v184
  v_cvt_pk_bf16_f32 v185, v185, v185
  v_and_b32 v185, 0xffff0000, v185
  v_sqrt_f32 v185, v185
  v_cvt_pk_bf16_f32 v186, v156, v157
  v_lshlrev_b32 v156, 16, v186
  v_and_b32 v157, 0xffff0000, v186
  v_cvt_pk_bf16_f32 v187, v158, v159
  v_lshlrev_b32 v158, 16, v187
  v_and_b32 v159, 0xffff0000, v187
  v_cvt_pk_bf16_f32 v185, v185, v185
  v_and_b32 v185, 0xffff0000, v185
  v_rcp_f32 v185, v185
  s_nop 0
  v_mul_f32 v156, v156, v185
  v_mul_f32 v157, v157, v185
  v_mul_f32 v158, v158, v185
  v_mul_f32 v159, v159, v185
  v_cvt_pk_bf16_f32 v186, v156, v157
  v_lshlrev_b32 v156, 16, v186
  v_and_b32 v157, 0xffff0000, v186
  v_cvt_pk_bf16_f32 v187, v158, v159
  v_lshlrev_b32 v158, 16, v187
  v_and_b32 v159, 0xffff0000, v187
  s_mov_b64 exec, -1
  s_cmp_lg_u32 s5, 2
  s_cbranch_scc1 Lx_110
  s_mov_b32 exec_lo, 0xffff
  s_mov_b32 exec_hi, 0x0
Lx_110:
  v_add_u32 v8, 0x1000, v13
  v_add_u32 v9, 0x2200, v13
  v_add_u32 v10, 0x3400, v13
  s_mov_b64 s[62:63], exec
  s_mov_b64 s[64:65], exec
  s_mov_b64 s[66:67], exec
  s_mov_b64 s[68:69], exec
  s_mov_b64 s[70:71], exec
  s_mov_b64 s[72:73], exec
  s_mov_b64 s[74:75], exec
  s_mov_b32 s15, 0
Lgr_111:
  s_mov_b64 exec, s[64:65]
  s_cbranch_execz Lgs_115
  buffer_load_dwordx4 v[196:199], v8, s[44:47], 0 offen offset:0 sc1
Lgs_115:
  s_mov_b64 exec, s[66:67]
  s_cbranch_execz Lgs_116
  buffer_load_dwordx4 v[200:203], v8, s[44:47], 0 offen offset:2304 sc1
Lgs_116:
  s_mov_b64 exec, s[68:69]
  s_cbranch_execz Lgs_117
  buffer_load_dwordx4 v[204:207], v9, s[44:47], 0 offen offset:0 sc1
Lgs_117:
  s_mov_b64 exec, s[70:71]
  s_cbranch_execz Lgs_118
  buffer_load_dwordx4 v[208:211], v9, s[44:47], 0 offen offset:2304 sc1
Lgs_118:
  s_mov_b64 exec, s[72:73]
  s_cbranch_execz Lgs_119
  buffer_load_dwordx4 v[212:215], v10, s[44:47], 0 offen offset:0 sc1
Lgs_119:
  s_mov_b64 exec, s[74:75]
  s_cbranch_execz Lgs_120
  buffer_load_dwordx4 v[216:219], v10, s[44:47], 0 offen offset:2304 sc1
Lgs_120:
Lgk_113:
  s_waitcnt vmcnt(0)
Lgk1_114:
  s_mov_b64 exec, s[64:65]
  s_cbranch_execz Lgc_121
  v_xor_b32 v6, v196, v14
  v_bitop3_b32 v6, v6, v197, v14 bitop3:0xf6
  v_bitop3_b32 v6, v6, v198, v14 bitop3:0xf6
  v_bitop3_b32 v6, v6, v199, v14 bitop3:0xf6
  v_and_b32 v6, 0xff, v6
  v_cmp_ne_u32 s[64:65], 0, v6
  v_and_b32 v196, 0xffffff00, v196
  v_and_b32 v197, 0xffffff00, v197
  v_and_b32 v198, 0xffffff00, v198
  v_and_b32 v199, 0xffffff00, v199
Lgc_121:
  s_mov_b64 exec, s[66:67]
  s_cbranch_execz Lgc_122
  v_xor_b32 v6, v200, v14
  v_bitop3_b32 v6, v6, v201, v14 bitop3:0xf6
  v_bitop3_b32 v6, v6, v202, v14 bitop3:0xf6
  v_bitop3_b32 v6, v6, v203, v14 bitop3:0xf6
  v_and_b32 v6, 0xff, v6
  v_cmp_ne_u32 s[66:67], 0, v6
  v_and_b32 v200, 0xffffff00, v200
  v_and_b32 v201, 0xffffff00, v201
  v_and_b32 v202, 0xffffff00, v202
  v_and_b32 v203, 0xffffff00, v203
Lgc_122:
  s_mov_b64 exec, s[68:69]
  s_cbranch_execz Lgc_123
  v_xor_b32 v6, v204, v14
  v_bitop3_b32 v6, v6, v205, v14 bitop3:0xf6
  v_bitop3_b32 v6, v6, v206, v14 bitop3:0xf6
  v_bitop3_b32 v6, v6, v207, v14 bitop3:0xf6
  v_and_b32 v6, 0xff, v6
  v_cmp_ne_u32 s[68:69], 0, v6
  v_and_b32 v204, 0xffffff00, v204
  v_and_b32 v205, 0xffffff00, v205
  v_and_b32 v206, 0xffffff00, v206
  v_and_b32 v207, 0xffffff00, v207
Lgc_123:
  s_mov_b64 exec, s[70:71]
  s_cbranch_execz Lgc_124
  v_xor_b32 v6, v208, v14
  v_bitop3_b32 v6, v6, v209, v14 bitop3:0xf6
  v_bitop3_b32 v6, v6, v210, v14 bitop3:0xf6
  v_bitop3_b32 v6, v6, v211, v14 bitop3:0xf6
  v_and_b32 v6, 0xff, v6
  v_cmp_ne_u32 s[70:71], 0, v6
  v_and_b32 v208, 0xffffff00, v208
  v_and_b32 v209, 0xffffff00, v209
  v_and_b32 v210, 0xffffff00, v210
  v_and_b32 v211, 0xffffff00, v211
Lgc_124:
  s_mov_b64 exec, s[72:73]
  s_cbranch_execz Lgc_125
  v_xor_b32 v6, v212, v14
  v_bitop3_b32 v6, v6, v213, v14 bitop3:0xf6
  v_bitop3_b32 v6, v6, v214, v14 bitop3:0xf6
  v_bitop3_b32 v6, v6, v215, v14 bitop3:0xf6
  v_and_b32 v6, 0xff, v6
  v_cmp_ne_u32 s[72:73], 0, v6
  v_and_b32 v212, 0xffffff00, v212
  v_and_b32 v213, 0xffffff00, v213
  v_and_b32 v214, 0xffffff00, v214
  v_and_b32 v215, 0xffffff00, v215
Lgc_125:
  s_mov_b64 exec, s[74:75]
  s_cbranch_execz Lgc_126
  v_xor_b32 v6, v216, v14
  v_bitop3_b32 v6, v6, v217, v14 bitop3:0xf6
  v_bitop3_b32 v6, v6, v218, v14 bitop3:0xf6
  v_bitop3_b32 v6, v6, v219, v14 bitop3:0xf6
  v_and_b32 v6, 0xff, v6
  v_cmp_ne_u32 s[74:75], 0, v6
  v_and_b32 v216, 0xffffff00, v216
  v_and_b32 v217, 0xffffff00, v217
  v_and_b32 v218, 0xffffff00, v218
  v_and_b32 v219, 0xffffff00, v219
Lgc_126:
  s_mov_b64 s[12:13], s[64:65]
  s_or_b64 s[12:13], s[12:13], s[66:67]
  s_or_b64 s[12:13], s[12:13], s[68:69]
  s_or_b64 s[12:13], s[12:13], s[70:71]
  s_or_b64 s[12:13], s[12:13], s[72:73]
  s_or_b64 s[12:13], s[12:13], s[74:75]
  s_cbranch_scc0 Lgd_112
  s_add_u32 s15, s15, 1
  s_sleep 1
  s_cmp_lt_u32 s15, 20000
  s_cbranch_scc1 Lgr_111
Lgd_112:
  s_mov_b64 exec, -1
  s_mov_b64 exec, s[62:63]
  v_pk_add_f32 v[196:197], v[196:197], v[204:205]
  v_pk_add_f32 v[198:199], v[198:199], v[206:207]
  v_pk_add_f32 v[200:201], v[200:201], v[208:209]
  v_pk_add_f32 v[202:203], v[202:203], v[210:211]
  v_pk_add_f32 v[196:197], v[196:197], v[212:213]
  v_pk_add_f32 v[198:199], v[198:199], v[214:215]
  v_pk_add_f32 v[200:201], v[200:201], v[216:217]
  v_pk_add_f32 v[202:203], v[202:203], v[218:219]
  v_cvt_pk_bf16_f32 v6, v196, v197
  v_lshlrev_b32 v196, 16, v6
  v_and_b32 v197, 0xffff0000, v6
  v_cvt_pk_bf16_f32 v7, v198, v199
  v_lshlrev_b32 v198, 16, v7
  v_and_b32 v199, 0xffff0000, v7
  v_cvt_pk_bf16_f32 v6, v200, v201
  v_lshlrev_b32 v200, 16, v6
  v_and_b32 v201, 0xffff0000, v6
  v_cvt_pk_bf16_f32 v7, v202, v203
  v_lshlrev_b32 v202, 16, v7
  v_and_b32 v203, 0xffff0000, v7
  v_add_f32 v200, 1.0, v200
  v_add_f32 v201, 1.0, v201
  v_add_f32 v202, 1.0, v202
  v_add_f32 v203, 1.0, v203
  v_cvt_pk_bf16_f32 v6, v200, v201
  v_lshlrev_b32 v200, 16, v6
  v_and_b32 v201, 0xffff0000, v6
  v_cvt_pk_bf16_f32 v7, v202, v203
  v_lshlrev_b32 v202, 16, v7
  v_and_b32 v203, 0xffff0000, v7
  v_mul_f32 v156, v156, v200
  v_mul_f32 v157, v157, v201
  v_mul_f32 v158, v158, v202
  v_mul_f32 v159, v159, v203
  v_cvt_pk_bf16_f32 v6, v156, v157
  v_lshlrev_b32 v156, 16, v6
  v_and_b32 v157, 0xffff0000, v6
  v_cvt_pk_bf16_f32 v7, v158, v159
  v_lshlrev_b32 v158, 16, v7
  v_and_b32 v159, 0xffff0000, v7
  v_add_f32 v156, v156, v196
  v_add_f32 v157, v157, v197
  v_add_f32 v158, v158, v198
  v_add_f32 v159, v159, v199
  v_cvt_pk_bf16_f32 v156, v156, v156
  v_cvt_pk_bf16_f32 v157, v157, v157
  v_cvt_pk_bf16_f32 v158, v158, v158
  v_cvt_pk_bf16_f32 v159, v159, v159
  ds_write_b32 v15, v156 offset:3200
  ds_write_b32 v15, v157 offset:3248
  ds_write_b32 v15, v158 offset:3296
  ds_write_b32 v15, v159 offset:3344
  s_mov_b64 exec, -1
Lh0_109:
  s_waitcnt lgkmcnt(0)
  s_barrier
  ds_read_b128 v[160:163], v241 offset:3200
  ds_read_b128 v[164:167], v241 offset:3216
  ds_read_b128 v[168:171], v241 offset:3232
  s_lshl_b32 s8, s98, 8
  s_add_u32 s8, s8, 0x10000
  v_add_u32 v9, s8, v242
  s_waitcnt vmcnt(0) lgkmcnt(0)
  v_and_b32 v184, v160, v2
  v_and_b32 v185, v160, v3
  v_and_b32 v186, v160, v4
  v_and_b32 v187, v160, v5
  v_and_b32 v188, v161, v2
  v_and_b32 v189, v161, v3
  v_and_b32 v190, v161, v4
  v_and_b32 v191, v161, v5
  v_mfma_f32_16x16x32_bf16 v[172:175], v[28:31], v[184:187], 0
  v_and_b32 v184, v162, v2
  v_and_b32 v185, v162, v3
  v_and_b32 v186, v162, v4
  v_and_b32 v187, v162, v5
  v_mfma_f32_16x16x32_bf16 v[172:175], v[32:35], v[188:191], v[172:175]
  v_and_b32 v188, v163, v2
  v_and_b32 v189, v163, v3
  v_and_b32 v190, v163, v4
  v_and_b32 v191, v163, v5
  v_mfma_f32_16x16x32_bf16 v[172:175], v[36:39], v[184:187], v[172:175]
  v_and_b32 v184, v164, v2
  v_and_b32 v185, v164, v3
  v_and_b32 v186, v164, v4
  v_and_b32 v187, v164, v5
  v_mfma_f32_16x16x32_bf16 v[172:175], v[40:43], v[188:191], v[172:175]
  v_and_b32 v188, v165, v2
  v_and_b32 v189, v165, v3
  v_and_b32 v190, v165, v4
  v_and_b32 v191, v165, v5
  v_mfma_f32_16x16x32_bf16 v[172:175], v[44:47], v[184:187], v[172:175]
  v_and_b32 v184, v166, v2
  v_and_b32 v185, v166, v3
  v_and_b32 v186, v166, v4
  v_and_b32 v187, v166, v5
  v_mfma_f32_16x16x32_bf16 v[172:175], v[48:51], v[188:191], v[172:175]
  v_and_b32 v188, v167, v2
  v_and_b32 v189, v167, v3
  v_and_b32 v190, v167, v4
  v_and_b32 v191, v167, v5
  v_mfma_f32_16x16x32_bf16 v[172:175], v[52:55], v[184:187], v[172:175]
  v_and_b32 v184, v168, v2
  v_and_b32 v185, v168, v3
  v_and_b32 v186, v168, v4
  v_and_b32 v187, v168, v5
  v_mfma_f32_16x16x32_bf16 v[172:175], v[56:59], v[188:191], v[172:175]
  s_nop 0
  v_mfma_f32_16x16x32_bf16 v[172:175], v[60:63], v[184:187], v[172:175]
  s_nop 7
  v_mov_b32 v184, v172
  v_mov_b32 v185, v173
  v_mov_b32 v186, v174
  v_mov_b32 v187, v175
  v_permlane32_swap_b32 v184, v172
  v_permlane32_swap_b32 v185, v173
  v_permlane32_swap_b32 v186, v174
  v_permlane32_swap_b32 v187, v175
  v_add_f32_dpp v172, v172, v184 row_ror:8 row_mask:0xf bank_mask:0xf
  v_add_f32_dpp v173, v173, v185 row_ror:8 row_mask:0xf bank_mask:0xf
  v_add_f32_dpp v174, v174, v186 row_ror:8 row_mask:0xf bank_mask:0xf
  v_add_f32_dpp v175, v175, v187 row_ror:8 row_mask:0xf bank_mask:0xf
  s_mov_b32 exec_lo, 0xff00ff
  s_mov_b32 exec_hi, 0x0
  ds_write_b128 v240, v[172:175] offset:7168
  s_mov_b64 exec, -1
  s_waitcnt lgkmcnt(0)
  s_barrier
  s_cmp_lg_u32 s5, 7
  s_cbranch_scc1 Lqp_127
  ds_read_b128 v[196:199], v247 offset:7168
  ds_read_b128 v[200:203], v247 offset:7424
  ds_read_b128 v[204:207], v247 offset:7680
  ds_read_b128 v[208:211], v247 offset:7936
  ds_read_b128 v[212:215], v247 offset:8192
  ds_read_b128 v[216:219], v247 offset:8448
  ds_read_b128 v[220:223], v247 offset:8704
  ds_read_b128 v[224:227], v247 offset:8960
  s_waitcnt lgkmcnt(0)
  v_pk_add_f32 v[196:197], v[196:197], v[200:201]
  v_pk_add_f32 v[198:199], v[198:199], v[202:203]
  v_pk_add_f32 v[204:205], v[204:205], v[208:209]
  v_pk_add_f32 v[206:207], v[206:207], v[210:211]
  v_pk_add_f32 v[212:213], v[212:213], v[216:217]
  v_pk_add_f32 v[214:215], v[214:215], v[218:219]
  v_pk_add_f32 v[220:221], v[220:221], v[224:225]
  v_pk_add_f32 v[222:223], v[222:223], v[226:227]
  v_pk_add_f32 v[196:197], v[196:197], v[204:205]
  v_pk_add_f32 v[198:199], v[198:199], v[206:207]
  v_pk_add_f32 v[212:213], v[212:213], v[220:221]
  v_pk_add_f32 v[214:215], v[214:215], v[222:223]
  v_pk_add_f32 v[196:197], v[196:197], v[212:213]
  v_pk_add_f32 v[198:199], v[198:199], v[214:215]
  v_cvt_pk_bf16_f32 v6, v196, v197
  v_lshlrev_b32 v196, 16, v6
  v_and_b32 v197, 0xffff0000, v6
  v_cvt_pk_bf16_f32 v7, v198, v199
  v_lshlrev_b32 v198, 16, v7
  v_and_b32 v199, 0xffff0000, v7
  v_bfi_b32 v196, s14, v14, v196
  v_bfi_b32 v197, s14, v14, v197
  v_bfi_b32 v198, s14, v14, v198
  v_bfi_b32 v199, s14, v14, v199
  s_mov_b32 exec_lo, 0xffff
  s_mov_b32 exec_hi, 0x0
  buffer_store_dwordx4 v[196:199], v9, s[44:47], 0 offen offset:0 sc1
  s_mov_b64 exec, -1
Lqp_127:
  s_barrier
  s_mov_b32 s56, s34
  s_mov_b32 s57, s35
  s_mov_b32 s58, 0x480
  s_mov_b32 s59, 0x00020000
  buffer_load_ushort v228, v248, s[56:59], 0 offen offset:0
  buffer_load_ushort v229, v248, s[56:59], 0 offen offset:128
  buffer_load_ushort v230, v248, s[56:59], 0 offen offset:256
  buffer_load_ushort v231, v248, s[56:59], 0 offen offset:384
  buffer_load_ushort v232, v248, s[56:59], 0 offen offset:512
  buffer_load_ushort v233, v248, s[56:59], 0 offen offset:640
  buffer_load_ushort v234, v248, s[56:59], 0 offen offset:768
  buffer_load_ushort v235, v248, s[56:59], 0 offen offset:896
  buffer_load_ushort v236, v248, s[56:59], 0 offen offset:1024
  s_cmp_ge_u32 s3, 48
  s_cbranch_scc1 L_Snotwo
  s_mov_b32 s52, s24
  s_mov_b32 s53, s25
  s_mov_b32 s54, 0x480000
  s_mov_b32 s55, 0x00020000
  s_mov_b32 s60, 9216
  s_mov_b32 s61, 18432
  s_mov_b32 s62, 27648
  buffer_load_dwordx4 v[64:67], v245, s[52:55], 0 offen offset:0 nt
  buffer_load_dwordx4 v[68:71], v245, s[52:55], s60 offen offset:0 nt
  buffer_load_dwordx4 v[72:75], v245, s[52:55], s61 offen offset:0 nt
  buffer_load_dwordx4 v[76:79], v245, s[52:55], s62 offen offset:0 nt
  buffer_load_dwordx4 v[80:83], v245, s[52:55], 0 offen offset:128 nt
  buffer_load_dwordx4 v[84:87], v245, s[52:55], s60 offen offset:128 nt
  buffer_load_dwordx4 v[88:91], v245, s[52:55], s61 offen offset:128 nt
  buffer_load_dwordx4 v[92:95], v245, s[52:55], s62 offen offset:128 nt
  buffer_load_dwordx4 v[96:99], v245, s[52:55], 0 offen offset:256 nt
  buffer_load_dwordx4 v[100:103], v245, s[52:55], s60 offen offset:256 nt
  buffer_load_dwordx4 v[104:107], v245, s[52:55], s61 offen offset:256 nt
  buffer_load_dwordx4 v[108:111], v245, s[52:55], s62 offen offset:256 nt
  s_mul_i32 s8, s4, 12288
  s_lshl_b32 s9, s5, 11
  s_add_u32 s8, s8, s9
  s_add_u32 s8, s8, 0x20000
  v_add_u32 v8, s8, v242
  s_mul_i32 s8, s4, 2304
  s_mul_i32 s9, s97, 768
  s_add_u32 s8, s8, s9
  s_add_u32 s8, s8, 0x60000
  v_add_u32 v10, s8, v242
  v_lshlrev_b32 v9, 4, v0
  v_lshrrev_b32 v12, 3, v1
  v_lshlrev_b32 v12, 4, v12
  s_lshl_b32 s8, s5, 7
  v_add_u32 v12, s8, v12
  s_waitcnt vmcnt(0)
  s_barrier
  s_cmp_ge_u32 s5, 6
  s_cbranch_scc1 Lg2s_128
  s_lshl_b32 s8, s4, 8
  s_add_u32 s8, s8, 0x50000
  v_min_u32 v7, 11, v1
  v_lshlrev_b32 v7, 4, v7
  v_add_u32 v7, s8, v7
  v_mov_b32 v216, v7
  s_mov_b32 s64, 0xffff
  s_mov_b32 s65, 0x0
  s_mov_b32 s15, 0
Lgr_129:
  s_mov_b64 exec, s[64:65]
  s_cbranch_execz Lgs_133
  buffer_load_dwordx4 v[204:207], v216, s[44:47], 0 offen offset:0 sc1
Lgs_133:
Lgk_131:
  s_waitcnt vmcnt(0)
Lgk1_132:
  s_mov_b64 exec, s[64:65]
  s_cbranch_execz Lgc_134
  v_xor_b32 v6, v204, v14
  v_bitop3_b32 v6, v6, v205, v14 bitop3:0xf6
  v_bitop3_b32 v6, v6, v206, v14 bitop3:0xf6
  v_bitop3_b32 v6, v6, v207, v14 bitop3:0xf6
  v_and_b32 v6, 0xff, v6
  v_cmp_ne_u32 s[64:65], 0, v6
  v_and_b32 v204, 0xffffff00, v204
  v_and_b32 v205, 0xffffff00, v205
  v_and_b32 v206, 0xffffff00, v206
  v_and_b32 v207, 0xffffff00, v207
Lgc_134:
  s_mov_b64 s[12:13], s[64:65]
  s_cmp_lg_u64 s[12:13], 0
  s_cbranch_scc0 Lgd_130
  s_add_u32 s15, s15, 1
  s_sleep 1
  s_cmp_lt_u32 s15, 20000
  s_cbranch_scc1 Lgr_129
Lgd_130:
  s_mov_b64 exec, -1
  v_mov_b32 v208, v204
  v_mov_b32 v209, v206
  s_nop 0
  v_max_f32_dpp v208, v208, v208 row_ror:8 row_mask:0xf bank_mask:0xf
  v_max_f32_dpp v209, v209, v209 row_ror:8 row_mask:0xf bank_mask:0xf
  s_nop 0
  v_max_f32_dpp v208, v208, v208 row_ror:4 row_mask:0xf bank_mask:0xf
  v_max_f32_dpp v209, v209, v209 row_ror:4 row_mask:0xf bank_mask:0xf
  s_nop 0
  v_max_f32_dpp v208, v208, v208 row_ror:2 row_mask:0xf bank_mask:0xf
  v_max_f32_dpp v209, v209, v209 row_ror:2 row_mask:0xf bank_mask:0xf
  s_nop 0
  v_max_f32_dpp v208, v208, v208 row_ror:1 row_mask:0xf bank_mask:0xf
  v_max_f32_dpp v209, v209, v209 row_ror:1 row_mask:0xf bank_mask:0xf
  s_mov_b32 s10, 0x3fb8aa3b
  v_sub_f32 v208, v204, v208
  v_sub_f32 v209, v206, v209
  v_mul_f32 v208, s10, v208
  v_mul_f32 v209, s10, v209
  v_exp_f32 v208, v208
  v_exp_f32 v209, v209
  v_cmp_gt_u32 vcc, 12, v1
  s_nop 1
  v_cndmask_b32 v208, 0, v208, vcc
  v_cndmask_b32 v209, 0, v209, vcc
  v_mul_f32 v210, v208, v205
  v_mul_f32 v211, v209, v207
  s_nop 0
  v_add_f32_dpp v210, v210, v210 row_ror:8 row_mask:0xf bank_mask:0xf
  v_add_f32_dpp v211, v211, v211 row_ror:8 row_mask:0xf bank_mask:0xf
  s_nop 0
  v_add_f32_dpp v210, v210, v210 row_ror:4 row_mask:0xf bank_mask:0xf
  v_add_f32_dpp v211, v211, v211 row_ror:4 row_mask:0xf bank_mask:0xf
  s_nop 0
  v_add_f32_dpp v210, v210, v210 row_ror:2 row_mask:0xf bank_mask:0xf
  v_add_f32_dpp v211, v211, v211 row_ror:2 row_mask:0xf bank_mask:0xf
  s_nop 0
  v_add_f32_dpp v210, v210, v210 row_ror:1 row_mask:0xf bank_mask:0xf
  v_add_f32_dpp v211, v211, v211 row_ror:1 row_mask:0xf bank_mask:0xf
  v_rcp_f32 v210, v210
  v_rcp_f32 v211, v211
  s_nop 0
  v_mul_f32 v208, v208, v210
  v_mul_f32 v209, v209, v211
  s_lshl_b32 s8, s5, 1
  s_add_u32 s9, s8, 1
  s_nop 0
  v_readlane_b32 s10, v208, s8
  v_readlane_b32 s11, v209, s8
  v_readlane_b32 s60, v208, s9
  v_readlane_b32 s61, v209, s9
  v_bfe_u32 v6, v1, 3, 1
  v_cmp_eq_u32 vcc, 1, v6
  v_mov_b32 v212, s10
  v_mov_b32 v213, s11
  v_mov_b32 v214, s60
  v_mov_b32 v215, s61
  v_cndmask_b32 v212, v212, v213, vcc
  v_cndmask_b32 v214, v214, v215, vcc
  s_mov_b64 s[64:65], -1
  s_mov_b64 s[66:67], -1
  s_mov_b32 s15, 0
Lgr_135:
  s_mov_b64 exec, s[64:65]
  s_cbranch_execz Lgs_139
  buffer_load_dwordx4 v[196:199], v8, s[44:47], 0 offen offset:0 sc1
Lgs_139:
  s_mov_b64 exec, s[66:67]
  s_cbranch_execz Lgs_140
  buffer_load_dwordx4 v[200:203], v8, s[44:47], 0 offen offset:1024 sc1
Lgs_140:
Lgk_137:
  s_waitcnt vmcnt(0)
Lgk1_138:
  s_mov_b64 exec, s[64:65]
  s_cbranch_execz Lgc_141
  v_xor_b32 v6, v196, v14
  v_bitop3_b32 v6, v6, v197, v14 bitop3:0xf6
  v_bitop3_b32 v6, v6, v198, v14 bitop3:0xf6
  v_bitop3_b32 v6, v6, v199, v14 bitop3:0xf6
  v_and_b32 v6, 0xff, v6
  v_cmp_ne_u32 s[64:65], 0, v6
  v_and_b32 v196, 0xffffff00, v196
  v_and_b32 v197, 0xffffff00, v197
  v_and_b32 v198, 0xffffff00, v198
  v_and_b32 v199, 0xffffff00, v199
Lgc_141:
  s_mov_b64 exec, s[66:67]
  s_cbranch_execz Lgc_142
  v_xor_b32 v6, v200, v14
  v_bitop3_b32 v6, v6, v201, v14 bitop3:0xf6
  v_bitop3_b32 v6, v6, v202, v14 bitop3:0xf6
  v_bitop3_b32 v6, v6, v203, v14 bitop3:0xf6
  v_and_b32 v6, 0xff, v6
  v_cmp_ne_u32 s[66:67], 0, v6
  v_and_b32 v200, 0xffffff00, v200
  v_and_b32 v201, 0xffffff00, v201
  v_and_b32 v202, 0xffffff00, v202
  v_and_b32 v203, 0xffffff00, v203
Lgc_142:
  s_mov_b64 s[12:13], s[64:65]
  s_or_b64 s[12:13], s[12:13], s[66:67]
  s_cbranch_scc0 Lgd_136
  s_add_u32 s15, s15, 1
  s_sleep 1
  s_cmp_lt_u32 s15, 20000
  s_cbranch_scc1 Lgr_135
Lgd_136:
  s_mov_b64 exec, -1
  v_mul_f32 v196, v196, v212
  v_mul_f32 v197, v197, v212
  v_mul_f32 v198, v198, v212
  v_mul_f32 v199, v199, v212
  v_fmac_f32 v196, v200, v214
  v_fmac_f32 v197, v201, v214
  v_fmac_f32 v198, v202, v214
  v_fmac_f32 v199, v203, v214
  ds_write_b128 v9, v[196:199] offset:13312
Lg2s_128:
  s_waitcnt lgkmcnt(0)
  s_barrier
  ds_read_b128 v[196:199], v12 offset:13312
  ds_read_b128 v[200:203], v12 offset:14336
  ds_read_b128 v[204:207], v12 offset:15360
  ds_read_b128 v[208:211], v12 offset:16384
  ds_read_b128 v[212:215], v12 offset:17408
  ds_read_b128 v[216:219], v12 offset:18432
  s_waitcnt lgkmcnt(0)
  v_pk_add_f32 v[196:197], v[196:197], v[200:201]
  v_pk_add_f32 v[198:199], v[198:199], v[202:203]
  v_pk_add_f32 v[204:205], v[204:205], v[208:209]
  v_pk_add_f32 v[206:207], v[206:207], v[210:211]
  v_pk_add_f32 v[212:213], v[212:213], v[216:217]
  v_pk_add_f32 v[214:215], v[214:215], v[218:219]
  v_pk_add_f32 v[196:197], v[196:197], v[204:205]
  v_pk_add_f32 v[198:199], v[198:199], v[206:207]
  v_pk_add_f32 v[196:197], v[196:197], v[212:213]
  v_pk_add_f32 v[198:199], v[198:199], v[214:215]
  v_cvt_pk_bf16_f32 v196, v196, v196
  v_cvt_pk_bf16_f32 v197, v197, v197
  v_cvt_pk_bf16_f32 v198, v198, v198
  v_cvt_pk_bf16_f32 v199, v199, v199
  v_and_b32 v184, v196, v2
  v_and_b32 v185, v196, v3
  v_and_b32 v186, v196, v4
  v_and_b32 v187, v196, v5
  v_and_b32 v188, v197, v2
  v_and_b32 v189, v197, v3
  v_and_b32 v190, v197, v4
  v_and_b32 v191, v197, v5
  v_mfma_f32_16x16x32_bf16 v[172:175], v[64:67], v[184:187], 0
  v_mfma_f32_16x16x32_bf16 v[176:179], v[80:83], v[184:187], 0
  v_mfma_f32_16x16x32_bf16 v[180:183], v[96:99], v[184:187], 0
  v_and_b32 v184, v198, v2
  v_and_b32 v185, v198, v3
  v_and_b32 v186, v198, v4
  v_and_b32 v187, v198, v5
  v_mfma_f32_16x16x32_bf16 v[172:175], v[68:71], v[188:191], v[172:175]
  v_mfma_f32_16x16x32_bf16 v[176:179], v[84:87], v[188:191], v[176:179]
  v_mfma_f32_16x16x32_bf16 v[180:183], v[100:103], v[188:191], v[180:183]
  v_and_b32 v188, v199, v2
  v_and_b32 v189, v199, v3
  v_and_b32 v190, v199, v4
  v_and_b32 v191, v199, v5
  v_mfma_f32_16x16x32_bf16 v[172:175], v[72:75], v[184:187], v[172:175]
  v_mfma_f32_16x16x32_bf16 v[176:179], v[88:91], v[184:187], v[176:179]
  v_mfma_f32_16x16x32_bf16 v[180:183], v[104:107], v[184:187], v[180:183]
  v_mfma_f32_16x16x32_bf16 v[172:175], v[76:79], v[188:191], v[172:175]
  v_mfma_f32_16x16x32_bf16 v[176:179], v[92:95], v[188:191], v[176:179]
  v_mfma_f32_16x16x32_bf16 v[180:183], v[108:111], v[188:191], v[180:183]
  s_nop 5
  v_mov_b32 v184, v172
  v_mov_b32 v185, v173
  v_mov_b32 v186, v174
  v_mov_b32 v187, v175
  v_mov_b32 v188, v176
  v_mov_b32 v189, v177
  v_mov_b32 v190, v178
  v_mov_b32 v191, v179
  v_mov_b32 v192, v180
  v_mov_b32 v193, v181
  v_mov_b32 v194, v182
  v_mov_b32 v195, v183
  v_permlane32_swap_b32 v184, v172
  v_permlane32_swap_b32 v185, v173
  v_permlane32_swap_b32 v186, v174
  v_permlane32_swap_b32 v187, v175
  v_permlane32_swap_b32 v188, v176
  v_permlane32_swap_b32 v189, v177
  v_permlane32_swap_b32 v190, v178
  v_permlane32_swap_b32 v191, v179
  v_permlane32_swap_b32 v192, v180
  v_permlane32_swap_b32 v193, v181
  v_permlane32_swap_b32 v194, v182
  v_permlane32_swap_b32 v195, v183
  v_add_f32_dpp v172, v172, v184 row_ror:8 row_mask:0xf bank_mask:0xf
  v_add_f32_dpp v173, v173, v185 row_ror:8 row_mask:0xf bank_mask:0xf
  v_add_f32_dpp v174, v174, v186 row_ror:8 row_mask:0xf bank_mask:0xf
  v_add_f32_dpp v175, v175, v187 row_ror:8 row_mask:0xf bank_mask:0xf
  v_add_f32_dpp v176, v176, v188 row_ror:8 row_mask:0xf bank_mask:0xf
  v_add_f32_dpp v177, v177, v189 row_ror:8 row_mask:0xf bank_mask:0xf
  v_add_f32_dpp v178, v178, v190 row_ror:8 row_mask:0xf bank_mask:0xf
  v_add_f32_dpp v179, v179, v191 row_ror:8 row_mask:0xf bank_mask:0xf
  v_add_f32_dpp v180, v180, v192 row_ror:8 row_mask:0xf bank_mask:0xf
  v_add_f32_dpp v181, v181, v193 row_ror:8 row_mask:0xf bank_mask:0xf
  v_add_f32_dpp v182, v182, v194 row_ror:8 row_mask:0xf bank_mask:0xf
  v_add_f32_dpp v183, v183, v195 row_ror:8 row_mask:0xf bank_mask:0xf
  s_mov_b32 exec_lo, 0xff00ff
  s_mov_b32 exec_hi, 0x0
  ds_write_b128 v240, v[172:175] offset:7168
  ds_write_b128 v240, v[176:179] offset:9216
  ds_write_b128 v240, v[180:183] offset:11264
  s_mov_b64 exec, -1
  s_waitcnt lgkmcnt(0)
  s_barrier
  s_cmp_lg_u32 s5, 0
  s_cbranch_scc1 Lap_143
  ds_read_b128 v[196:199], v247 offset:7168
  ds_read_b128 v[200:203], v247 offset:7424
  ds_read_b128 v[204:207], v247 offset:7680
  ds_read_b128 v[208:211], v247 offset:7936
  ds_read_b128 v[212:215], v247 offset:8192
  ds_read_b128 v[216:219], v247 offset:8448
  ds_read_b128 v[220:223], v247 offset:8704
  ds_read_b128 v[224:227], v247 offset:8960
  s_waitcnt lgkmcnt(0)
  v_pk_add_f32 v[196:197], v[196:197], v[200:201]
  v_pk_add_f32 v[198:199], v[198:199], v[202:203]
  v_pk_add_f32 v[204:205], v[204:205], v[208:209]
  v_pk_add_f32 v[206:207], v[206:207], v[210:211]
  v_pk_add_f32 v[212:213], v[212:213], v[216:217]
  v_pk_add_f32 v[214:215], v[214:215], v[218:219]
  v_pk_add_f32 v[220:221], v[220:221], v[224:225]
  v_pk_add_f32 v[222:223], v[222:223], v[226:227]
  v_pk_add_f32 v[196:197], v[196:197], v[204:205]
  v_pk_add_f32 v[198:199], v[198:199], v[206:207]
  v_pk_add_f32 v[212:213], v[212:213], v[220:221]
  v_pk_add_f32 v[214:215], v[214:215], v[222:223]
  v_pk_add_f32 v[196:197], v[196:197], v[212:213]
  v_pk_add_f32 v[198:199], v[198:199], v[214:215]
  v_bfi_b32 v196, s14, v14, v196
  v_bfi_b32 v197, s14, v14, v197
  v_bfi_b32 v198, s14, v14, v198
  v_bfi_b32 v199, s14, v14, v199
  s_mov_b32 exec_lo, 0xffffffff
  s_mov_b32 exec_hi, 0xffff
  buffer_store_dwordx4 v[196:199], v10, s[44:47], 0 offen offset:0 sc1
  s_mov_b64 exec, -1
Lap_143:
  s_branch L_Sred
L_Snotwo:
  s_sub_u32 s96, s3, 48
  s_add_u32 s97, s96, 16
  s_lshl_b32 s8, s96, 7
  s_add_u32 s8, s8, 2304
  v_lshrrev_b32 v6, 3, v1
  s_lshl_b32 s11, s5, 3
  v_add_u32 v6, s11, v6
  v_mul_u32_u24 v6, 6912, v6
  v_and_b32 v7, 7, v1
  v_lshlrev_b32 v7, 4, v7
  v_add3_u32 v246, v6, v7, s8
  v_add_u32 v6, 0, v246
  buffer_load_dwordx4 v[64:67], v6, s[48:51], 0 offen nt
  v_add_u32 v6, 442368, v246
  buffer_load_dwordx4 v[68:71], v6, s[48:51], 0 offen nt
  v_add_u32 v6, 884736, v246
  buffer_load_dwordx4 v[72:75], v6, s[48:51], 0 offen nt
  v_add_u32 v6, 1327104, v246
  buffer_load_dwordx4 v[76:79], v6, s[48:51], 0 offen nt
  v_add_u32 v6, 1769472, v246
  buffer_load_dwordx4 v[80:83], v6, s[48:51], 0 offen nt
  v_add_u32 v6, 2211840, v246
  buffer_load_dwordx4 v[84:87], v6, s[48:51], 0 offen nt
  v_add_u32 v6, 2654208, v246
  buffer_load_dwordx4 v[88:91], v6, s[48:51], 0 offen nt
  v_add_u32 v6, 3096576, v246
  buffer_load_dwordx4 v[92:95], v6, s[48:51], 0 offen nt
  v_add_u32 v6, 3538944, v246
  buffer_load_dwordx4 v[96:99], v6, s[48:51], 0 offen nt
  s_barrier
  s_lshl_b32 s8, s97, 7
  s_add_u32 s8, s8, 2304
  v_lshrrev_b32 v6, 3, v1
  s_lshl_b32 s11, s5, 3
  v_add_u32 v6, s11, v6
  v_mul_u32_u24 v6, 6912, v6
  v_and_b32 v7, 7, v1
  v_lshlrev_b32 v7, 4, v7
  v_add3_u32 v246, v6, v7, s8
  v_add_u32 v6, 0, v246
  buffer_load_dwordx4 v[112:115], v6, s[48:51], 0 offen nt
  v_add_u32 v6, 442368, v246
  buffer_load_dwordx4 v[116:119], v6, s[48:51], 0 offen nt
  v_add_u32 v6, 884736, v246
  buffer_load_dwordx4 v[120:123], v6, s[48:51], 0 offen nt
  v_add_u32 v6, 1327104, v246
  buffer_load_dwordx4 v[124:127], v6, s[48:51], 0 offen nt
  v_add_u32 v6, 1769472, v246
  buffer_load_dwordx4 v[128:131], v6, s[48:51], 0 offen nt
  v_add_u32 v6, 2211840, v246
  buffer_load_dwordx4 v[132:135], v6, s[48:51], 0 offen nt
  v_add_u32 v6, 2654208, v246
  buffer_load_dwordx4 v[136:139], v6, s[48:51], 0 offen nt
  v_add_u32 v6, 3096576, v246
  buffer_load_dwordx4 v[140:143], v6, s[48:51], 0 offen nt
  v_add_u32 v6, 3538944, v246
  buffer_load_dwordx4 v[144:147], v6, s[48:51], 0 offen nt
  s_waitcnt vmcnt(18)
  v_lshlrev_b32 v228, 16, v228
  v_lshlrev_b32 v229, 16, v229
  v_lshlrev_b32 v230, 16, v230
  v_mul_f32 v6, 0xbfb8aa3b, v228
  v_mul_f32 v7, 0xbfb8aa3b, v229
  v_mul_f32 v8, 0xbfb8aa3b, v230
  v_exp_f32 v6, v6
  v_exp_f32 v7, v7
  v_exp_f32 v8, v8
  v_add_f32 v6, 1.0, v6
  v_add_f32 v7, 1.0, v7
  v_add_f32 v8, 1.0, v8
  v_rcp_f32 v6, v6
  v_rcp_f32 v7, v7
  v_rcp_f32 v8, v8
  v_mul_f32 v228, v228, v6
  v_mul_f32 v229, v229, v7
  v_mul_f32 v230, v230, v8
  v_cvt_pk_bf16_f32 v228, v228, v228
  v_cvt_pk_bf16_f32 v229, v229, v229
  v_cvt_pk_bf16_f32 v230, v230, v230
  v_lshlrev_b32 v231, 16, v231
  v_lshlrev_b32 v232, 16, v232
  v_lshlrev_b32 v233, 16, v233
  v_mul_f32 v6, 0xbfb8aa3b, v231
  v_mul_f32 v7, 0xbfb8aa3b, v232
  v_mul_f32 v8, 0xbfb8aa3b, v233
  v_exp_f32 v6, v6
  v_exp_f32 v7, v7
  v_exp_f32 v8, v8
  v_add_f32 v6, 1.0, v6
  v_add_f32 v7, 1.0, v7
  v_add_f32 v8, 1.0, v8
  v_rcp_f32 v6, v6
  v_rcp_f32 v7, v7
  v_rcp_f32 v8, v8
  v_mul_f32 v231, v231, v6
  v_mul_f32 v232, v232, v7
  v_mul_f32 v233, v233, v8
  v_cvt_pk_bf16_f32 v231, v231, v231
  v_cvt_pk_bf16_f32 v232, v232, v232
  v_cvt_pk_bf16_f32 v233, v233, v233
  v_lshlrev_b32 v234, 16, v234
  v_lshlrev_b32 v235, 16, v235
  v_lshlrev_b32 v236, 16, v236
  v_mul_f32 v6, 0xbfb8aa3b, v234
  v_mul_f32 v7, 0xbfb8aa3b, v235
  v_mul_f32 v8, 0xbfb8aa3b, v236
  v_exp_f32 v6, v6
  v_exp_f32 v7, v7
  v_exp_f32 v8, v8
  v_add_f32 v6, 1.0, v6
  v_add_f32 v7, 1.0, v7
  v_add_f32 v8, 1.0, v8
  v_rcp_f32 v6, v6
  v_rcp_f32 v7, v7
  v_rcp_f32 v8, v8
  v_mul_f32 v234, v234, v6
  v_mul_f32 v235, v235, v7
  v_mul_f32 v236, v236, v8
  v_cvt_pk_bf16_f32 v234, v234, v234
  v_cvt_pk_bf16_f32 v235, v235, v235
  v_cvt_pk_bf16_f32 v236, v236, v236
  s_barrier
  s_waitcnt vmcnt(9)
  v_and_b32 v184, v228, v2
  v_and_b32 v185, v228, v3
  v_and_b32 v186, v228, v4
  v_and_b32 v187, v228, v5
  v_and_b32 v188, v229, v2
  v_and_b32 v189, v229, v3
  v_and_b32 v190, v229, v4
  v_and_b32 v191, v229, v5
  v_mfma_f32_16x16x32_bf16 v[172:175], v[64:67], v[184:187], 0
  v_and_b32 v184, v230, v2
  v_and_b32 v185, v230, v3
  v_and_b32 v186, v230, v4
  v_and_b32 v187, v230, v5
  v_mfma_f32_16x16x32_bf16 v[172:175], v[68:71], v[188:191], v[172:175]
  v_and_b32 v188, v231, v2
  v_and_b32 v189, v231, v3
  v_and_b32 v190, v231, v4
  v_and_b32 v191, v231, v5
  v_mfma_f32_16x16x32_bf16 v[172:175], v[72:75], v[184:187], v[172:175]
  v_and_b32 v184, v232, v2
  v_and_b32 v185, v232, v3
  v_and_b32 v186, v232, v4
  v_and_b32 v187, v232, v5
  v_mfma_f32_16x16x32_bf16 v[172:175], v[76:79], v[188:191], v[172:175]
  v_and_b32 v188, v233, v2
  v_and_b32 v189, v233, v3
  v_and_b32 v190, v233, v4
  v_and_b32 v191, v233, v5
  v_mfma_f32_16x16x32_bf16 v[172:175], v[80:83], v[184:187], v[172:175]
  v_and_b32 v184, v234, v2
  v_and_b32 v185, v234, v3
  v_and_b32 v186, v234, v4
  v_and_b32 v187, v234, v5
  v_mfma_f32_16x16x32_bf16 v[172:175], v[84:87], v[188:191], v[172:175]
  v_and_b32 v188, v235, v2
  v_and_b32 v189, v235, v3
  v_and_b32 v190, v235, v4
  v_and_b32 v191, v235, v5
  v_mfma_f32_16x16x32_bf16 v[172:175], v[88:91], v[184:187], v[172:175]
  v_and_b32 v184, v236, v2
  v_and_b32 v185, v236, v3
  v_and_b32 v186, v236, v4
  v_and_b32 v187, v236, v5
  v_mfma_f32_16x16x32_bf16 v[172:175], v[92:95], v[188:191], v[172:175]
  s_nop 0
  v_mfma_f32_16x16x32_bf16 v[172:175], v[96:99], v[184:187], v[172:175]
  s_nop 7
  v_mov_b32 v184, v172
  v_mov_b32 v185, v173
  v_mov_b32 v186, v174
  v_mov_b32 v187, v175
  v_permlane32_swap_b32 v184, v172
  v_permlane32_swap_b32 v185, v173
  v_permlane32_swap_b32 v186, v174
  v_permlane32_swap_b32 v187, v175
  v_add_f32_dpp v172, v172, v184 row_ror:8 row_mask:0xf bank_mask:0xf
  v_add_f32_dpp v173, v173, v185 row_ror:8 row_mask:0xf bank_mask:0xf
  v_add_f32_dpp v174, v174, v186 row_ror:8 row_mask:0xf bank_mask:0xf
  v_add_f32_dpp v175, v175, v187 row_ror:8 row_mask:0xf bank_mask:0xf
  s_mov_b32 exec_lo, 0xff00ff
  s_mov_b32 exec_hi, 0x0
  ds_write_b128 v240, v[172:175] offset:7168
  s_mov_b64 exec, -1
  s_waitcnt lgkmcnt(0)
  s_barrier
  s_cmp_lg_u32 s5, 7
  s_cbranch_scc1 Lmrp_144
  ds_read_b128 v[196:199], v247 offset:7168
  ds_read_b128 v[200:203], v247 offset:7424
  ds_read_b128 v[204:207], v247 offset:7680
  ds_read_b128 v[208:211], v247 offset:7936
  ds_read_b128 v[212:215], v247 offset:8192
  ds_read_b128 v[216:219], v247 offset:8448
  ds_read_b128 v[220:223], v247 offset:8704
  ds_read_b128 v[224:227], v247 offset:8960
  s_waitcnt lgkmcnt(0)
  v_pk_add_f32 v[196:197], v[196:197], v[200:201]
  v_pk_add_f32 v[198:199], v[198:199], v[202:203]
  v_pk_add_f32 v[204:205], v[204:205], v[208:209]
  v_pk_add_f32 v[206:207], v[206:207], v[210:211]
  v_pk_add_f32 v[212:213], v[212:213], v[216:217]
  v_pk_add_f32 v[214:215], v[214:215], v[218:219]
  v_pk_add_f32 v[220:221], v[220:221], v[224:225]
  v_pk_add_f32 v[222:223], v[222:223], v[226:227]
  v_pk_add_f32 v[196:197], v[196:197], v[204:205]
  v_pk_add_f32 v[198:199], v[198:199], v[206:207]
  v_pk_add_f32 v[212:213], v[212:213], v[220:221]
  v_pk_add_f32 v[214:215], v[214:215], v[222:223]
  v_pk_add_f32 v[196:197], v[196:197], v[212:213]
  v_pk_add_f32 v[198:199], v[198:199], v[214:215]
  v_cvt_pk_bf16_f32 v6, v196, v197
  v_lshlrev_b32 v196, 16, v6
  v_and_b32 v197, 0xffff0000, v6
  v_cvt_pk_bf16_f32 v7, v198, v199
  v_lshlrev_b32 v198, 16, v7
  v_and_b32 v199, 0xffff0000, v7
  v_bfi_b32 v196, s14, v14, v196
  v_bfi_b32 v197, s14, v14, v197
  v_bfi_b32 v198, s14, v14, v198
  v_bfi_b32 v199, s14, v14, v199
  v_mov_b32 v6, s96
  v_lshlrev_b32 v6, 8, v6
  v_and_b32 v7, 15, v1
  v_lshl_add_u32 v6, v7, 4, v6
  v_add_u32 v6, 0x8000, v6
  s_mov_b32 exec_lo, 0xffff
  s_mov_b32 exec_hi, 0x0
  buffer_store_dwordx4 v[196:199], v6, s[44:47], 0 offen offset:0 sc1
  s_mov_b64 exec, -1
Lmrp_144:
  s_barrier
  s_waitcnt vmcnt(0)
  v_and_b32 v184, v228, v2
  v_and_b32 v185, v228, v3
  v_and_b32 v186, v228, v4
  v_and_b32 v187, v228, v5
  v_and_b32 v188, v229, v2
  v_and_b32 v189, v229, v3
  v_and_b32 v190, v229, v4
  v_and_b32 v191, v229, v5
  v_mfma_f32_16x16x32_bf16 v[172:175], v[112:115], v[184:187], 0
  v_and_b32 v184, v230, v2
  v_and_b32 v185, v230, v3
  v_and_b32 v186, v230, v4
  v_and_b32 v187, v230, v5
  v_mfma_f32_16x16x32_bf16 v[172:175], v[116:119], v[188:191], v[172:175]
  v_and_b32 v188, v231, v2
  v_and_b32 v189, v231, v3
  v_and_b32 v190, v231, v4
  v_and_b32 v191, v231, v5
  v_mfma_f32_16x16x32_bf16 v[172:175], v[120:123], v[184:187], v[172:175]
  v_and_b32 v184, v232, v2
  v_and_b32 v185, v232, v3
  v_and_b32 v186, v232, v4
  v_and_b32 v187, v232, v5
  v_mfma_f32_16x16x32_bf16 v[172:175], v[124:127], v[188:191], v[172:175]
  v_and_b32 v188, v233, v2
  v_and_b32 v189, v233, v3
  v_and_b32 v190, v233, v4
  v_and_b32 v191, v233, v5
  v_mfma_f32_16x16x32_bf16 v[172:175], v[128:131], v[184:187], v[172:175]
  v_and_b32 v184, v234, v2
  v_and_b32 v185, v234, v3
  v_and_b32 v186, v234, v4
  v_and_b32 v187, v234, v5
  v_mfma_f32_16x16x32_bf16 v[172:175], v[132:135], v[188:191], v[172:175]
  v_and_b32 v188, v235, v2
  v_and_b32 v189, v235, v3
  v_and_b32 v190, v235, v4
  v_and_b32 v191, v235, v5
  v_mfma_f32_16x16x32_bf16 v[172:175], v[136:139], v[184:187], v[172:175]
  v_and_b32 v184, v236, v2
  v_and_b32 v185, v236, v3
  v_and_b32 v186, v236, v4
  v_and_b32 v187, v236, v5
  v_mfma_f32_16x16x32_bf16 v[172:175], v[140:143], v[188:191], v[172:175]
  s_nop 0
  v_mfma_f32_16x16x32_bf16 v[172:175], v[144:147], v[184:187], v[172:175]
  s_nop 7
  v_mov_b32 v184, v172
  v_mov_b32 v185, v173
  v_mov_b32 v186, v174
  v_mov_b32 v187, v175
  v_permlane32_swap_b32 v184, v172
  v_permlane32_swap_b32 v185, v173
  v_permlane32_swap_b32 v186, v174
  v_permlane32_swap_b32 v187, v175
  v_add_f32_dpp v172, v172, v184 row_ror:8 row_mask:0xf bank_mask:0xf
  v_add_f32_dpp v173, v173, v185 row_ror:8 row_mask:0xf bank_mask:0xf
  v_add_f32_dpp v174, v174, v186 row_ror:8 row_mask:0xf bank_mask:0xf
  v_add_f32_dpp v175, v175, v187 row_ror:8 row_mask:0xf bank_mask:0xf
  s_mov_b32 exec_lo, 0xff00ff
  s_mov_b32 exec_hi, 0x0
  ds_write_b128 v240, v[172:175] offset:7168
  s_mov_b64 exec, -1
  s_waitcnt lgkmcnt(0)
  s_barrier
  s_cmp_lg_u32 s5, 7
  s_cbranch_scc1 Lmrp_145
  ds_read_b128 v[196:199], v247 offset:7168
  ds_read_b128 v[200:203], v247 offset:7424
  ds_read_b128 v[204:207], v247 offset:7680
  ds_read_b128 v[208:211], v247 offset:7936
  ds_read_b128 v[212:215], v247 offset:8192
  ds_read_b128 v[216:219], v247 offset:8448
  ds_read_b128 v[220:223], v247 offset:8704
  ds_read_b128 v[224:227], v247 offset:8960
  s_waitcnt lgkmcnt(0)
  v_pk_add_f32 v[196:197], v[196:197], v[200:201]
  v_pk_add_f32 v[198:199], v[198:199], v[202:203]
  v_pk_add_f32 v[204:205], v[204:205], v[208:209]
  v_pk_add_f32 v[206:207], v[206:207], v[210:211]
  v_pk_add_f32 v[212:213], v[212:213], v[216:217]
  v_pk_add_f32 v[214:215], v[214:215], v[218:219]
  v_pk_add_f32 v[220:221], v[220:221], v[224:225]
  v_pk_add_f32 v[222:223], v[222:223], v[226:227]
  v_pk_add_f32 v[196:197], v[196:197], v[204:205]
  v_pk_add_f32 v[198:199], v[198:199], v[206:207]
  v_pk_add_f32 v[212:213], v[212:213], v[220:221]
  v_pk_add_f32 v[214:215], v[214:215], v[222:223]
  v_pk_add_f32 v[196:197], v[196:197], v[212:213]
  v_pk_add_f32 v[198:199], v[198:199], v[214:215]
  v_cvt_pk_bf16_f32 v6, v196, v197
  v_lshlrev_b32 v196, 16, v6
  v_and_b32 v197, 0xffff0000, v6
  v_cvt_pk_bf16_f32 v7, v198, v199
  v_lshlrev_b32 v198, 16, v7
  v_and_b32 v199, 0xffff0000, v7
  v_bfi_b32 v196, s14, v14, v196
  v_bfi_b32 v197, s14, v14, v197
  v_bfi_b32 v198, s14, v14, v198
  v_bfi_b32 v199, s14, v14, v199
  v_mov_b32 v6, s97
  v_lshlrev_b32 v6, 8, v6
  v_and_b32 v7, 15, v1
  v_lshl_add_u32 v6, v7, 4, v6
  v_add_u32 v6, 0x8000, v6
  s_mov_b32 exec_lo, 0xffff
  s_mov_b32 exec_hi, 0x0
  buffer_store_dwordx4 v[196:199], v6, s[44:47], 0 offen offset:0 sc1
  s_mov_b64 exec, -1
Lmrp_145:
  s_barrier
  s_cmp_ge_u32 s3, 52
  s_cbranch_scc1 L_Send
  s_sub_u32 s96, s3, 16
  s_lshl_b32 s8, s96, 7
  s_add_u32 s8, s8, 2304
  v_lshrrev_b32 v6, 3, v1
  s_lshl_b32 s11, s5, 3
  v_add_u32 v6, s11, v6
  v_mul_u32_u24 v6, 6912, v6
  v_and_b32 v7, 7, v1
  v_lshlrev_b32 v7, 4, v7
  v_add3_u32 v246, v6, v7, s8
  v_add_u32 v6, 0, v246
  buffer_load_dwordx4 v[64:67], v6, s[48:51], 0 offen nt
  v_add_u32 v6, 442368, v246
  buffer_load_dwordx4 v[68:71], v6, s[48:51], 0 offen nt
  v_add_u32 v6, 884736, v246
  buffer_load_dwordx4 v[72:75], v6, s[48:51], 0 offen nt
  v_add_u32 v6, 1327104, v246
  buffer_load_dwordx4 v[76:79], v6, s[48:51], 0 offen nt
  v_add_u32 v6, 1769472, v246
  buffer_load_dwordx4 v[80:83], v6, s[48:51], 0 offen nt
  v_add_u32 v6, 2211840, v246
  buffer_load_dwordx4 v[84:87], v6, s[48:51], 0 offen nt
  v_add_u32 v6, 2654208, v246
  buffer_load_dwordx4 v[88:91], v6, s[48:51], 0 offen nt
  v_add_u32 v6, 3096576, v246
  buffer_load_dwordx4 v[92:95], v6, s[48:51], 0 offen nt
  v_add_u32 v6, 3538944, v246
  buffer_load_dwordx4 v[96:99], v6, s[48:51], 0 offen nt
  s_barrier
  s_waitcnt vmcnt(0)
  v_and_b32 v184, v228, v2
  v_and_b32 v185, v228, v3
  v_and_b32 v186, v228, v4
  v_and_b32 v187, v228, v5
  v_and_b32 v188, v229, v2
  v_and_b32 v189, v229, v3
  v_and_b32 v190, v229, v4
  v_and_b32 v191, v229, v5
  v_mfma_f32_16x16x32_bf16 v[172:175], v[64:67], v[184:187], 0
  v_and_b32 v184, v230, v2
  v_and_b32 v185, v230, v3
  v_and_b32 v186, v230, v4
  v_and_b32 v187, v230, v5
  v_mfma_f32_16x16x32_bf16 v[172:175], v[68:71], v[188:191], v[172:175]
  v_and_b32 v188, v231, v2
  v_and_b32 v189, v231, v3
  v_and_b32 v190, v231, v4
  v_and_b32 v191, v231, v5
  v_mfma_f32_16x16x32_bf16 v[172:175], v[72:75], v[184:187], v[172:175]
  v_and_b32 v184, v232, v2
  v_and_b32 v185, v232, v3
  v_and_b32 v186, v232, v4
  v_and_b32 v187, v232, v5
  v_mfma_f32_16x16x32_bf16 v[172:175], v[76:79], v[188:191], v[172:175]
  v_and_b32 v188, v233, v2
  v_and_b32 v189, v233, v3
  v_and_b32 v190, v233, v4
  v_and_b32 v191, v233, v5
  v_mfma_f32_16x16x32_bf16 v[172:175], v[80:83], v[184:187], v[172:175]
  v_and_b32 v184, v234, v2
  v_and_b32 v185, v234, v3
  v_and_b32 v186, v234, v4
  v_and_b32 v187, v234, v5
  v_mfma_f32_16x16x32_bf16 v[172:175], v[84:87], v[188:191], v[172:175]
  v_and_b32 v188, v235, v2
  v_and_b32 v189, v235, v3
  v_and_b32 v190, v235, v4
  v_and_b32 v191, v235, v5
  v_mfma_f32_16x16x32_bf16 v[172:175], v[88:91], v[184:187], v[172:175]
  v_and_b32 v184, v236, v2
  v_and_b32 v185, v236, v3
  v_and_b32 v186, v236, v4
  v_and_b32 v187, v236, v5
  v_mfma_f32_16x16x32_bf16 v[172:175], v[92:95], v[188:191], v[172:175]
  s_nop 0
  v_mfma_f32_16x16x32_bf16 v[172:175], v[96:99], v[184:187], v[172:175]
  s_nop 7
  v_mov_b32 v184, v172
  v_mov_b32 v185, v173
  v_mov_b32 v186, v174
  v_mov_b32 v187, v175
  v_permlane32_swap_b32 v184, v172
  v_permlane32_swap_b32 v185, v173
  v_permlane32_swap_b32 v186, v174
  v_permlane32_swap_b32 v187, v175
  v_add_f32_dpp v172, v172, v184 row_ror:8 row_mask:0xf bank_mask:0xf
  v_add_f32_dpp v173, v173, v185 row_ror:8 row_mask:0xf bank_mask:0xf
  v_add_f32_dpp v174, v174, v186 row_ror:8 row_mask:0xf bank_mask:0xf
  v_add_f32_dpp v175, v175, v187 row_ror:8 row_mask:0xf bank_mask:0xf
  s_mov_b32 exec_lo, 0xff00ff
  s_mov_b32 exec_hi, 0x0
  ds_write_b128 v240, v[172:175] offset:7168
  s_mov_b64 exec, -1
  s_waitcnt lgkmcnt(0)
  s_barrier
  s_cmp_lg_u32 s5, 7
  s_cbranch_scc1 Lmrp_146
  ds_read_b128 v[196:199], v247 offset:7168
  ds_read_b128 v[200:203], v247 offset:7424
  ds_read_b128 v[204:207], v247 offset:7680
  ds_read_b128 v[208:211], v247 offset:7936
  ds_read_b128 v[212:215], v247 offset:8192
  ds_read_b128 v[216:219], v247 offset:8448
  ds_read_b128 v[220:223], v247 offset:8704
  ds_read_b128 v[224:227], v247 offset:8960
  s_waitcnt lgkmcnt(0)
  v_pk_add_f32 v[196:197], v[196:197], v[200:201]
  v_pk_add_f32 v[198:199], v[198:199], v[202:203]
  v_pk_add_f32 v[204:205], v[204:205], v[208:209]
  v_pk_add_f32 v[206:207], v[206:207], v[210:211]
  v_pk_add_f32 v[212:213], v[212:213], v[216:217]
  v_pk_add_f32 v[214:215], v[214:215], v[218:219]
  v_pk_add_f32 v[220:221], v[220:221], v[224:225]
  v_pk_add_f32 v[222:223], v[222:223], v[226:227]
  v_pk_add_f32 v[196:197], v[196:197], v[204:205]
  v_pk_add_f32 v[198:199], v[198:199], v[206:207]
  v_pk_add_f32 v[212:213], v[212:213], v[220:221]
  v_pk_add_f32 v[214:215], v[214:215], v[222:223]
  v_pk_add_f32 v[196:197], v[196:197], v[212:213]
  v_pk_add_f32 v[198:199], v[198:199], v[214:215]
  v_cvt_pk_bf16_f32 v6, v196, v197
  v_lshlrev_b32 v196, 16, v6
  v_and_b32 v197, 0xffff0000, v6
  v_cvt_pk_bf16_f32 v7, v198, v199
  v_lshlrev_b32 v198, 16, v7
  v_and_b32 v199, 0xffff0000, v7
  v_bfi_b32 v196, s14, v14, v196
  v_bfi_b32 v197, s14, v14, v197
  v_bfi_b32 v198, s14, v14, v198
  v_bfi_b32 v199, s14, v14, v199
  v_mov_b32 v6, s96
  v_lshlrev_b32 v6, 8, v6
  v_and_b32 v7, 15, v1
  v_lshl_add_u32 v6, v7, 4, v6
  v_add_u32 v6, 0x8000, v6
  s_mov_b32 exec_lo, 0xffff
  s_mov_b32 exec_hi, 0x0
  buffer_store_dwordx4 v[196:199], v6, s[44:47], 0 offen offset:0 sc1
  s_mov_b64 exec, -1
Lmrp_146:
  s_branch L_Send
L_Sred:
  s_cmp_ge_u32 s3, 36
  s_cbranch_scc1 L_Send
  s_mul_i32 s8, s5, 73728
  s_lshl_b32 s9, s3, 6
  s_add_u32 s8, s8, s9
  s_add_u32 s8, s8, 0x80000
  v_lshrrev_b32 v6, 2, v1
  v_mul_u32_u24 v6, 2304, v6
  v_and_b32 v7, 3, v1
  v_lshlrev_b32 v7, 4, v7
  v_add3_u32 v144, v6, v7, s8
  v_add_u32 v145, 36864, v144
  s_cmp_ge_u32 s5, 3
  s_cbranch_scc1 Lrm_147
  v_add_u32 v97, 0x8000, v13
  v_add_u32 v98, 0x9b00, v13
  s_mov_b64 s[62:63], -1
  s_cmp_lg_u32 s5, 2
  s_cbranch_scc1 Lmp_148
  s_mov_b32 s62, 0xffff
  s_mov_b32 s63, 0
Lmp_148:
  s_mov_b64 exec, s[62:63]
  s_mov_b64 s[64:65], exec
  s_mov_b64 s[66:67], exec
  s_mov_b32 s15, 0
Lgr_149:
  s_mov_b64 exec, s[64:65]
  s_cbranch_execz Lgs_153
  buffer_load_dwordx4 v[80:83], v97, s[44:47], 0 offen offset:0 sc1
Lgs_153:
  s_mov_b64 exec, s[66:67]
  s_cbranch_execz Lgs_154
  buffer_load_dwordx4 v[84:87], v98, s[44:47], 0 offen offset:0 sc1
Lgs_154:
Lgk_151:
  s_waitcnt vmcnt(0)
Lgk1_152:
  s_mov_b64 exec, s[64:65]
  s_cbranch_execz Lgc_155
  v_xor_b32 v96, v80, v14
  v_bitop3_b32 v96, v96, v81, v14 bitop3:0xf6
  v_bitop3_b32 v96, v96, v82, v14 bitop3:0xf6
  v_bitop3_b32 v96, v96, v83, v14 bitop3:0xf6
  v_and_b32 v96, 0xff, v96
  v_cmp_ne_u32 s[64:65], 0, v96
  v_and_b32 v80, 0xffff0000, v80
  v_and_b32 v81, 0xffff0000, v81
  v_and_b32 v82, 0xffff0000, v82
  v_and_b32 v83, 0xffff0000, v83
Lgc_155:
  s_mov_b64 exec, s[66:67]
  s_cbranch_execz Lgc_156
  v_xor_b32 v96, v84, v14
  v_bitop3_b32 v96, v96, v85, v14 bitop3:0xf6
  v_bitop3_b32 v96, v96, v86, v14 bitop3:0xf6
  v_bitop3_b32 v96, v96, v87, v14 bitop3:0xf6
  v_and_b32 v96, 0xff, v96
  v_cmp_ne_u32 s[66:67], 0, v96
  v_and_b32 v84, 0xffff0000, v84
  v_and_b32 v85, 0xffff0000, v85
  v_and_b32 v86, 0xffff0000, v86
  v_and_b32 v87, 0xffff0000, v87
Lgc_156:
  s_mov_b64 s[12:13], s[64:65]
  s_or_b64 s[12:13], s[12:13], s[66:67]
  s_cbranch_scc0 Lgd_150
  s_add_u32 s15, s15, 1
  s_sleep 1
  s_cmp_lt_u32 s15, 20000
  s_cbranch_scc1 Lgr_149
Lgd_150:
  s_mov_b64 exec, -1
Lrm_147:
  s_mul_i32 s8, s5, 4608
  s_add_u32 s8, s8, 0x60000
  v_add_u32 v97, s8, v242
  v_add_u32 v98, 2304, v97
  s_mul_i32 s8, s5, 2304
  v_add_u32 v99, s8, v242
  v_mov_b32 v24, 0
  v_mov_b32 v36, 0
  v_mov_b32 v25, 0
  v_mov_b32 v37, 0
  v_mov_b32 v26, 0
  v_mov_b32 v38, 0
  v_mov_b32 v27, 0
  v_mov_b32 v39, 0
  s_mov_b64 s[64:65], -1
  s_mov_b64 s[66:67], -1
  s_mov_b32 s68, 0xffff
  s_mov_b32 s69, 0x0
  s_mov_b64 s[70:71], -1
  s_mov_b64 s[72:73], -1
  s_mov_b32 s74, 0xffff
  s_mov_b32 s75, 0x0
  s_mov_b32 s15, 0
Lgr_157:
  s_mov_b64 exec, s[64:65]
  s_cbranch_execz Lgs_161
  buffer_load_dwordx4 v[16:19], v97, s[44:47], 0 offen offset:0 sc1
Lgs_161:
  s_mov_b64 exec, s[66:67]
  s_cbranch_execz Lgs_162
  buffer_load_dwordx4 v[20:23], v97, s[44:47], 0 offen offset:1024 sc1
Lgs_162:
  s_mov_b64 exec, s[68:69]
  s_cbranch_execz Lgs_163
  buffer_load_dwordx4 v[24:27], v97, s[44:47], 0 offen offset:2048 sc1
Lgs_163:
  s_mov_b64 exec, s[70:71]
  s_cbranch_execz Lgs_164
  buffer_load_dwordx4 v[28:31], v98, s[44:47], 0 offen offset:0 sc1
Lgs_164:
  s_mov_b64 exec, s[72:73]
  s_cbranch_execz Lgs_165
  buffer_load_dwordx4 v[32:35], v98, s[44:47], 0 offen offset:1024 sc1
Lgs_165:
  s_mov_b64 exec, s[74:75]
  s_cbranch_execz Lgs_166
  buffer_load_dwordx4 v[36:39], v98, s[44:47], 0 offen offset:2048 sc1
Lgs_166:
Lgk_159:
  s_waitcnt vmcnt(0)
Lgk1_160:
  s_mov_b64 exec, s[64:65]
  s_cbranch_execz Lgc_167
  v_xor_b32 v96, v16, v14
  v_bitop3_b32 v96, v96, v17, v14 bitop3:0xf6
  v_bitop3_b32 v96, v96, v18, v14 bitop3:0xf6
  v_bitop3_b32 v96, v96, v19, v14 bitop3:0xf6
  v_and_b32 v96, 0xff, v96
  v_cmp_ne_u32 s[64:65], 0, v96
  v_and_b32 v16, 0xffffff00, v16
  v_and_b32 v17, 0xffffff00, v17
  v_and_b32 v18, 0xffffff00, v18
  v_and_b32 v19, 0xffffff00, v19
Lgc_167:
  s_mov_b64 exec, s[66:67]
  s_cbranch_execz Lgc_168
  v_xor_b32 v96, v20, v14
  v_bitop3_b32 v96, v96, v21, v14 bitop3:0xf6
  v_bitop3_b32 v96, v96, v22, v14 bitop3:0xf6
  v_bitop3_b32 v96, v96, v23, v14 bitop3:0xf6
  v_and_b32 v96, 0xff, v96
  v_cmp_ne_u32 s[66:67], 0, v96
  v_and_b32 v20, 0xffffff00, v20
  v_and_b32 v21, 0xffffff00, v21
  v_and_b32 v22, 0xffffff00, v22
  v_and_b32 v23, 0xffffff00, v23
Lgc_168:
  s_mov_b64 exec, s[68:69]
  s_cbranch_execz Lgc_169
  v_xor_b32 v96, v24, v14
  v_bitop3_b32 v96, v96, v25, v14 bitop3:0xf6
  v_bitop3_b32 v96, v96, v26, v14 bitop3:0xf6
  v_bitop3_b32 v96, v96, v27, v14 bitop3:0xf6
  v_and_b32 v96, 0xff, v96
  v_cmp_ne_u32 s[68:69], 0, v96
  v_and_b32 v24, 0xffffff00, v24
  v_and_b32 v25, 0xffffff00, v25
  v_and_b32 v26, 0xffffff00, v26
  v_and_b32 v27, 0xffffff00, v27
Lgc_169:
  s_mov_b64 exec, s[70:71]
  s_cbranch_execz Lgc_170
  v_xor_b32 v96, v28, v14
  v_bitop3_b32 v96, v96, v29, v14 bitop3:0xf6
  v_bitop3_b32 v96, v96, v30, v14 bitop3:0xf6
  v_bitop3_b32 v96, v96, v31, v14 bitop3:0xf6
  v_and_b32 v96, 0xff, v96
  v_cmp_ne_u32 s[70:71], 0, v96
  v_and_b32 v28, 0xffffff00, v28
  v_and_b32 v29, 0xffffff00, v29
  v_and_b32 v30, 0xffffff00, v30
  v_and_b32 v31, 0xffffff00, v31
Lgc_170:
  s_mov_b64 exec, s[72:73]
  s_cbranch_execz Lgc_171
  v_xor_b32 v96, v32, v14
  v_bitop3_b32 v96, v96, v33, v14 bitop3:0xf6
  v_bitop3_b32 v96, v96, v34, v14 bitop3:0xf6
  v_bitop3_b32 v96, v96, v35, v14 bitop3:0xf6
  v_and_b32 v96, 0xff, v96
  v_cmp_ne_u32 s[72:73], 0, v96
  v_and_b32 v32, 0xffffff00, v32
  v_and_b32 v33, 0xffffff00, v33
  v_and_b32 v34, 0xffffff00, v34
  v_and_b32 v35, 0xffffff00, v35
Lgc_171:
  s_mov_b64 exec, s[74:75]
  s_cbranch_execz Lgc_172
  v_xor_b32 v96, v36, v14
  v_bitop3_b32 v96, v96, v37, v14 bitop3:0xf6
  v_bitop3_b32 v96, v96, v38, v14 bitop3:0xf6
  v_bitop3_b32 v96, v96, v39, v14 bitop3:0xf6
  v_and_b32 v96, 0xff, v96
  v_cmp_ne_u32 s[74:75], 0, v96
  v_and_b32 v36, 0xffffff00, v36
  v_and_b32 v37, 0xffffff00, v37
  v_and_b32 v38, 0xffffff00, v38
  v_and_b32 v39, 0xffffff00, v39
Lgc_172:
  s_mov_b64 s[12:13], s[64:65]
  s_or_b64 s[12:13], s[12:13], s[66:67]
  s_or_b64 s[12:13], s[12:13], s[68:69]
  s_or_b64 s[12:13], s[12:13], s[70:71]
  s_or_b64 s[12:13], s[12:13], s[72:73]
  s_or_b64 s[12:13], s[12:13], s[74:75]
  s_cbranch_scc0 Lgd_158
  s_add_u32 s15, s15, 1
  s_sleep 1
  s_cmp_lt_u32 s15, 20000
  s_cbranch_scc1 Lgr_157
Lgd_158:
  s_mov_b64 exec, -1
  v_pk_add_f32 v[16:17], v[16:17], v[28:29]
  v_pk_add_f32 v[18:19], v[18:19], v[30:31]
  v_pk_add_f32 v[20:21], v[20:21], v[32:33]
  v_pk_add_f32 v[22:23], v[22:23], v[34:35]
  v_pk_add_f32 v[24:25], v[24:25], v[36:37]
  v_pk_add_f32 v[26:27], v[26:27], v[38:39]
  ds_write_b128 v99, v[16:19] offset:24576
  ds_write_b128 v99, v[20:23] offset:25600
  s_mov_b32 exec_lo, 0xffff
  s_mov_b32 exec_hi, 0x0
  ds_write_b128 v99, v[24:27] offset:26624
  s_mov_b64 exec, -1
  s_waitcnt lgkmcnt(0)
  s_barrier
  s_cmp_ge_u32 s5, 3
  s_cbranch_scc1 Lrx_173
  s_mov_b64 exec, -1
  s_cmp_lg_u32 s5, 2
  s_cbranch_scc1 Lx_174
  s_mov_b32 exec_lo, 0xffff
  s_mov_b32 exec_hi, 0x0
Lx_174:
  ds_read_b128 v[16:19], v13 offset:24576
  ds_read_b128 v[20:23], v13 offset:26880
  ds_read_b128 v[24:27], v13 offset:29184
  ds_read_b128 v[28:31], v13 offset:31488
  ds_read_b128 v[32:35], v13 offset:33792
  ds_read_b128 v[36:39], v13 offset:36096
  ds_read_b128 v[40:43], v13 offset:38400
  ds_read_b128 v[44:47], v13 offset:40704
  s_waitcnt lgkmcnt(0)
  v_pk_add_f32 v[16:17], v[16:17], v[20:21]
  v_pk_add_f32 v[18:19], v[18:19], v[22:23]
  v_pk_add_f32 v[24:25], v[24:25], v[28:29]
  v_pk_add_f32 v[26:27], v[26:27], v[30:31]
  v_pk_add_f32 v[32:33], v[32:33], v[36:37]
  v_pk_add_f32 v[34:35], v[34:35], v[38:39]
  v_pk_add_f32 v[40:41], v[40:41], v[44:45]
  v_pk_add_f32 v[42:43], v[42:43], v[46:47]
  v_pk_add_f32 v[16:17], v[16:17], v[24:25]
  v_pk_add_f32 v[18:19], v[18:19], v[26:27]
  v_pk_add_f32 v[32:33], v[32:33], v[40:41]
  v_pk_add_f32 v[34:35], v[34:35], v[42:43]
  v_pk_add_f32 v[16:17], v[16:17], v[32:33]
  v_pk_add_f32 v[18:19], v[18:19], v[34:35]
  v_cvt_pk_bf16_f32 v96, v16, v17
  v_lshlrev_b32 v16, 16, v96
  v_and_b32 v17, 0xffff0000, v96
  v_cvt_pk_bf16_f32 v97, v18, v19
  v_lshlrev_b32 v18, 16, v97
  v_and_b32 v19, 0xffff0000, v97
  v_mul_f32 v16, v80, v16
  v_mul_f32 v17, v81, v17
  v_mul_f32 v18, v82, v18
  v_mul_f32 v19, v83, v19
  v_cvt_pk_bf16_f32 v96, v16, v17
  v_lshlrev_b32 v16, 16, v96
  v_and_b32 v17, 0xffff0000, v96
  v_cvt_pk_bf16_f32 v97, v18, v19
  v_lshlrev_b32 v18, 16, v97
  v_and_b32 v19, 0xffff0000, v97
  v_add_f32 v112, v152, v16
  v_add_f32 v113, v153, v17
  v_add_f32 v114, v154, v18
  v_add_f32 v115, v155, v19
  v_cvt_pk_bf16_f32 v96, v112, v113
  v_lshlrev_b32 v112, 16, v96
  v_and_b32 v113, 0xffff0000, v96
  v_cvt_pk_bf16_f32 v97, v114, v115
  v_lshlrev_b32 v114, 16, v97
  v_and_b32 v115, 0xffff0000, v97
  v_lshlrev_b32 v6, 5, v0
  ds_write_b128 v6, v[112:115] offset:13312
  ds_write_b128 v6, v[84:87] offset:13328
  s_mov_b64 exec, -1
Lrx_173:
  s_waitcnt lgkmcnt(0)
  s_barrier
  v_lshrrev_b32 v6, 2, v1
  v_and_b32 v6, 3, v6
  s_lshl_b32 s8, s3, 2
  v_add_u32 v8, s8, v6
  v_and_b32 v7, 3, v1
  v_lshlrev_b32 v9, 5, v8
  v_lshl_add_u32 v9, v7, 2, v9
  ds_read_b32 v148, v9 offset:13312
  ds_read_b32 v149, v9 offset:13328
  v_lshrrev_b32 v6, 4, v8
  v_lshlrev_b32 v6, 7, v6
  v_bfe_u32 v9, v8, 3, 1
  v_lshlrev_b32 v9, 6, v9
  v_and_b32 v10, 7, v8
  v_lshlrev_b32 v10, 1, v10
  v_add3_u32 v6, v6, v9, v10
  v_lshl_add_u32 v150, v7, 4, v6
  v_and_b32 v6, 15, v1
  v_lshlrev_b32 v151, 2, v6
  s_lshl_b32 s8, s5, 6
  v_add_u32 v152, s8, v242
  s_mov_b32 s56, s38
  s_mov_b32 s57, s39
  s_mov_b32 s58, 0x480
  s_mov_b32 s59, 0x00020000
  s_cmp_ge_u32 s5, 6
  s_cbranch_scc1 Lh4_175
  s_mov_b64 s[64:65], -1
  s_mov_b64 s[66:67], -1
  s_mov_b32 s15, 0
Lgr_176:
  s_mov_b64 exec, s[64:65]
  s_cbranch_execz Lgs_180
  buffer_load_dwordx4 v[128:131], v144, s[44:47], 0 offen offset:0 sc1
Lgs_180:
  s_mov_b64 exec, s[66:67]
  s_cbranch_execz Lgs_181
  buffer_load_dwordx4 v[132:135], v145, s[44:47], 0 offen offset:0 sc1
Lgs_181:
Lgk_178:
  s_waitcnt vmcnt(0)
Lgk1_179:
  s_mov_b64 exec, s[64:65]
  s_cbranch_execz Lgc_182
  v_xor_b32 v6, v128, v14
  v_bitop3_b32 v6, v6, v129, v14 bitop3:0xf6
  v_bitop3_b32 v6, v6, v130, v14 bitop3:0xf6
  v_bitop3_b32 v6, v6, v131, v14 bitop3:0xf6
  v_and_b32 v6, 0xff, v6
  v_cmp_ne_u32 s[64:65], 0, v6
  v_and_b32 v128, 0xffffff00, v128
  v_and_b32 v129, 0xffffff00, v129
  v_and_b32 v130, 0xffffff00, v130
  v_and_b32 v131, 0xffffff00, v131
Lgc_182:
  s_mov_b64 exec, s[66:67]
  s_cbranch_execz Lgc_183
  v_xor_b32 v6, v132, v14
  v_bitop3_b32 v6, v6, v133, v14 bitop3:0xf6
  v_bitop3_b32 v6, v6, v134, v14 bitop3:0xf6
  v_bitop3_b32 v6, v6, v135, v14 bitop3:0xf6
  v_and_b32 v6, 0xff, v6
  v_cmp_ne_u32 s[66:67], 0, v6
  v_and_b32 v132, 0xffffff00, v132
  v_and_b32 v133, 0xffffff00, v133
  v_and_b32 v134, 0xffffff00, v134
  v_and_b32 v135, 0xffffff00, v135
Lgc_183:
  s_mov_b64 s[12:13], s[64:65]
  s_or_b64 s[12:13], s[12:13], s[66:67]
  s_cbranch_scc0 Lgd_177
  s_add_u32 s15, s15, 1
  s_sleep 1
  s_cmp_lt_u32 s15, 20000
  s_cbranch_scc1 Lgr_176
Lgd_177:
  s_mov_b64 exec, -1
  v_pk_add_f32 v[128:129], v[128:129], v[132:133]
  v_pk_add_f32 v[130:131], v[130:131], v[134:135]
  s_nop 0
  v_add_f32_dpp v128, v128, v128 row_ror:4 row_mask:0xf bank_mask:0xf
  v_add_f32_dpp v129, v129, v129 row_ror:4 row_mask:0xf bank_mask:0xf
  v_add_f32_dpp v130, v130, v130 row_ror:4 row_mask:0xf bank_mask:0xf
  v_add_f32_dpp v131, v131, v131 row_ror:4 row_mask:0xf bank_mask:0xf
  v_add_f32_dpp v128, v128, v128 row_ror:8 row_mask:0xf bank_mask:0xf
  v_add_f32_dpp v129, v129, v129 row_ror:8 row_mask:0xf bank_mask:0xf
  v_add_f32_dpp v130, v130, v130 row_ror:8 row_mask:0xf bank_mask:0xf
  v_add_f32_dpp v131, v131, v131 row_ror:8 row_mask:0xf bank_mask:0xf
  v_mov_b32 v132, v128
  v_mov_b32 v133, v129
  v_mov_b32 v134, v130
  v_mov_b32 v135, v131
  v_permlane32_swap_b32 v132, v128
  v_permlane32_swap_b32 v133, v129
  v_permlane32_swap_b32 v134, v130
  v_permlane32_swap_b32 v135, v131
  v_add_f32 v128, v128, v132
  v_add_f32 v129, v129, v133
  v_add_f32 v130, v130, v134
  v_add_f32 v131, v131, v135
  v_mov_b32 v132, v128
  v_mov_b32 v133, v129
  v_mov_b32 v134, v130
  v_mov_b32 v135, v131
  v_permlane16_swap_b32 v132, v128
  v_permlane16_swap_b32 v133, v129
  v_permlane16_swap_b32 v134, v130
  v_permlane16_swap_b32 v135, v131
  v_add_f32 v128, v128, v132
  v_add_f32 v129, v129, v133
  v_add_f32 v130, v130, v134
  v_add_f32 v131, v131, v135
  s_mov_b64 exec, 15
  ds_write_b128 v152, v[128:131] offset:7168
  s_mov_b64 exec, -1
Lh4_175:
  s_waitcnt lgkmcnt(0)
  s_barrier
  s_cmp_lg_u32 s5, 0
  s_cbranch_scc1 L_Send
  ds_read_b32 v128, v151 offset:7168
  ds_read_b32 v129, v151 offset:7232
  ds_read_b32 v130, v151 offset:7296
  ds_read_b32 v131, v151 offset:7360
  ds_read_b32 v132, v151 offset:7424
  ds_read_b32 v133, v151 offset:7488
  s_waitcnt lgkmcnt(0)
  v_add_f32 v128, v128, v129
  v_add_f32 v130, v130, v131
  v_add_f32 v132, v132, v133
  v_add_f32 v128, v128, v130
  v_add_f32 v128, v128, v132
  v_cvt_pk_bf16_f32 v128, v128, v128
  v_and_b32 v128, 0xffff0000, v128
  v_mul_f32 v128, v149, v128
  v_cvt_pk_bf16_f32 v128, v128, v128
  v_and_b32 v128, 0xffff0000, v128
  v_add_f32 v128, v148, v128
  v_cvt_pk_bf16_f32 v128, v128, v128
  s_mov_b32 exec_lo, 0xffff
  s_mov_b32 exec_hi, 0
  buffer_store_short v128, v150, s[56:59], 0 offen
  s_cmp_lg_u32 s3, 0
  s_cbranch_scc1 L_Send
  s_add_u32 s8, s7, 1
  v_mov_b32 v6, s8
  v_mov_b32 v7, 0
  s_mov_b64 exec, 1
  buffer_store_dword v6, v7, s[44:47], 0 offen
L_Send:
  s_endpgm
L_end:
  s_endpgm
.section .rodata,"a"
.p2align 6
.amdhsa_kernel adaLN_cond__sliding_block_cached__geglu_ffn__decode_kernel
  .amdhsa_next_free_vgpr 256
  .amdhsa_next_free_sgpr 102
  .amdhsa_accum_offset 256
  .amdhsa_group_segment_fixed_size 0
  .amdhsa_kernarg_size 112
  .amdhsa_user_sgpr_count 2
  .amdhsa_user_sgpr_kernarg_segment_ptr 1
  .amdhsa_system_sgpr_workgroup_id_x 1
.end_amdhsa_kernel
```
